```python
import torch

def _softmax(x, axis=-1):
    return torch.softmax(x, dim=axis)
def _gelu(x):
    return torch.nn.functional.gelu(x, approximate="tanh")
def _silu(x):
    return torch.nn.functional.silu(x)
def _sigmoid(x):
    return torch.sigmoid(x)
def _layernorm(x, axis=-1, eps=1e-5):
    m = x.mean(dim=axis, keepdim=True)
    v = x.var(dim=axis, keepdim=True, unbiased=False)
    return (x - m) / torch.sqrt(v + eps)
def _scatter_add(tgt, idx, src, axis=0):
    return tgt.clone().index_add_(axis, idx, src)
def _segment_sum(src, seg, n):
    out = torch.zeros((n,) + src.shape[1:], dtype=src.dtype)
    return out.index_add_(0, seg, src)
def _pad(x, pw):
    flat = tuple(v for pair in reversed(pw) for v in pair)
    return torch.nn.functional.pad(x, flat)

kernel_name = 'parallel_sum__sliding_block_cached__mixer_channel_mlp__decode'

def setup_inputs():

    _w = (lambda a: (lambda t: t.to(torch.bfloat16) if t.is_floating_point() else t)(torch.as_tensor(a)))
    def _A_setup():
        B, Sq, D = 1, 1, 576
        Hq, Hkv, Sk, Dh = 32, 16, 65536, 128
        assert Hq % Hkv == 0, (Hq, Hkv)
        return {
            "x": _w((lambda *s: torch.randn(*s, dtype=torch.bfloat16) * 0.05)(B, Sq, D)),
            "k_cache": _w((lambda *s: torch.randn(*s, dtype=torch.bfloat16) * 3.2)(B, Hkv, Sk, Dh)),
            "v_cache": _w((lambda *s: torch.randn(*s, dtype=torch.bfloat16) * 0.4)(B, Hkv, Sk, Dh)),
            "wq": _w((lambda *s: torch.randn(*s, dtype=torch.bfloat16) * 3.2)(D, Hq * Dh) * (D ** -0.5)),
            "wo": _w((lambda *s: torch.randn(*s, dtype=torch.bfloat16) * 0.4)(Hq * Dh, D) * ((Hq * Dh) ** -0.5)),
        }
    _A_in = _A_setup()

    def _B_setup():
        B, S, D, F = 1, 1, 576, 4608
        return {
            "x": _w((lambda *s: torch.randn(*s, dtype=torch.bfloat16) * 0.05)(B, S, D)),
            "w1": _w((lambda *s: torch.randn(*s, dtype=torch.bfloat16) * 3.2)(D, F) * (D ** -0.5)),
            "b1": _w((lambda *s: torch.randn(*s, dtype=torch.bfloat16) * 0.8)(F)),
            "w2": _w((lambda *s: torch.randn(*s, dtype=torch.bfloat16) * 0.1)(F, D) * (F ** -0.5)),
            "b2": _w((lambda *s: torch.randn(*s, dtype=torch.bfloat16) * 0.1)(D)),
        }
    _B_in = _B_setup()

    return {
        "A_x": _A_in["x"],
        "A_k_cache": _A_in["k_cache"],
        "A_v_cache": _A_in["v_cache"],
        "A_wq": _A_in["wq"],
        "A_wo": _A_in["wo"],
        "B_x": _B_in["x"],
        "B_w1": _B_in["w1"],
        "B_b1": _B_in["b1"],
        "B_w2": _B_in["w2"],
        "B_b2": _B_in["b2"],
    }

def reference(A_x, A_k_cache, A_v_cache, A_wq, A_wo, B_x, B_w1, B_b1, B_w2, B_b2):
    def _A_ref(x, k_cache, v_cache, wq, wo):
        B, Sq, D = x.shape
        Hq, Dh = 32, 128
        Hkv, Sk = k_cache.shape[1], k_cache.shape[2]
        W = min(4096, max(256, Sk // 4))
        rep = Hq // Hkv
        q = (lambda x, *d: x.permute(*d))((x @ wq).reshape(B, Sq, Hq, Dh), 0, 2, 1, 3)
        k = (lambda x, n, axis: torch.repeat_interleave(x, n, dim=axis))(k_cache[:, :, Sk - W:, :], rep, axis=1)
        v = (lambda x, n, axis: torch.repeat_interleave(x, n, dim=axis))(v_cache[:, :, Sk - W:, :], rep, axis=1)
        scores = torch.einsum("bhqd,bhkd->bhqk", q, k) * (Dh ** -0.5)
        p = _softmax(scores, axis=-1)
        o = torch.einsum("bhqk,bhkd->bhqd", p, v)
        return (lambda x, *d: x.permute(*d))(o, 0, 2, 1, 3).reshape(B, Sq, Hq * Dh) @ wo

    def _B_ref(x, w1, b1, w2, b2):
        y = _layernorm(x, axis=-1)
        h = _gelu(torch.einsum("bsd,df->bsf", y, w1) + b1)
        return torch.einsum("bsf,fd->bsd", h, w2) + b2

    x = A_x
    xn = _layernorm(x, axis=-1)
    return x + _A_ref(xn, A_k_cache, A_v_cache, A_wq, A_wo) + _B_ref(xn, B_w1, B_b1, B_w2, B_b2)
```

```asm
; @launch grid=(256,1,1) block=(768,1,1) lds=49664
.amdgcn_target "amdgcn-amd-amdhsa--gfx950"
.text
.globl parallel_sum__sliding_block_cached__mixer_channel_mlp__decode_kernel
.p2align 8
.type parallel_sum__sliding_block_cached__mixer_channel_mlp__decode_kernel,@function
parallel_sum__sliding_block_cached__mixer_channel_mlp__decode_kernel:
    s_cmp_ge_u32 s2, 256
    s_cbranch_scc1 L_end
    s_load_dwordx16 s[36:51], s[0:1], 0
    s_load_dwordx8 s[52:59], s[0:1], 64
    s_load_dwordx2 s[60:61], s[0:1], 96
    v_and_b32 v1, 63, v0
    v_lshrrev_b32 v2, 6, v0
    s_nop 1
    v_readfirstlane_b32 s3, v2
    s_lshr_b32 s4, s2, 4
    s_and_b32 s5, s2, 15
    s_mov_b32 s24, 0x3fb8aa3b
    s_mov_b32 s25, 0xffff0000
    s_waitcnt lgkmcnt(0)
    s_mov_b32 s88, s60
    s_and_b32 s89, s61, 0xffff
    s_mov_b32 s90, 1073741824
    s_mov_b32 s91, 0x20000
    s_cmp_lt_u32 s3, 4
    s_cbranch_scc1 L_roles
L_kv:
    s_mov_b32 s64, s38
    s_and_b32 s65, s39, 0xffff
    s_mov_b32 s66, 268435456
    s_mov_b32 s67, 0x20000
    s_sub_u32 s7, s3, 4
    s_lshl_b32 s9, s4, 24
    s_lshl_b32 s10, s5, 16
    s_add_u32 s9, s9, s10
    s_add_u32 s9, s9, 15728640
    s_lshl_b32 s10, s7, 13
    s_add_u32 s9, s9, s10
    s_add_u32 s10, s9, 4096
    v_and_b32 v10, 15, v1
    v_lshrrev_b32 v11, 4, v1
    v_lshlrev_b32 v3, 8, v10
    v_lshl_add_u32 v3, v11, 4, v3
    v_lshlrev_b32 v12, 11, v11
    v_lshl_add_u32 v12, v10, 4, v12
    s_mov_b32 s14, 0
    v_mov_b32 v8, 3076
    buffer_load_dwordx4 v[16:19], v12, s[64:67], s9 offen offset:0 nt
    buffer_load_dwordx4 v[20:23], v12, s[64:67], s9 offen offset:256 nt
    buffer_load_dwordx4 v[24:27], v12, s[64:67], s9 offen offset:512 nt
    s_branch L_kvb
L_roles:
    s_cmp_eq_u32 s3, 2
    s_cbranch_scc1 L_sync
    s_cmp_lg_u32 s3, 0
    s_cbranch_scc1 L_h
    s_mov_b32 s72, s42
    s_and_b32 s73, s43, 0xffff
    s_mov_b32 s74, 4718592
    s_mov_b32 s75, 0x20000
    v_lshlrev_b32 v3, 4, v1
    global_load_dwordx4 v[4:7], v3, s[36:37]
    v_lshlrev_b32 v9, 1, v1
    global_load_ushort v8, v9, s[36:37] offset:1024
    v_lshrrev_b32 v19, 3, v1
    v_and_b32 v2, 7, v1
    v_lshlrev_b32 v116, 13, v19
    v_lshl_add_u32 v116, v2, 4, v116
    s_and_b32 s8, s2, 3
    s_mul_i32 s8, s8, 144
    s_lshl_b32 s9, s8, 13
    s_lshr_b32 s10, s2, 2
    s_lshl_b32 s10, s10, 7
    s_add_u32 s9, s9, s10
    buffer_load_dwordx4 v[32:35], v116, s[72:75], s9 offen nt
    s_add_u32 s9, s9, 65536
    buffer_load_dwordx4 v[36:39], v116, s[72:75], s9 offen nt
    s_add_u32 s9, s9, 65536
    buffer_load_dwordx4 v[40:43], v116, s[72:75], s9 offen nt
    s_add_u32 s9, s9, 65536
    buffer_load_dwordx4 v[44:47], v116, s[72:75], s9 offen nt
    s_add_u32 s9, s9, 65536
    buffer_load_dwordx4 v[48:51], v116, s[72:75], s9 offen nt
    s_add_u32 s9, s9, 65536
    buffer_load_dwordx4 v[52:55], v116, s[72:75], s9 offen nt
    s_add_u32 s9, s9, 65536
    buffer_load_dwordx4 v[56:59], v116, s[72:75], s9 offen nt
    s_add_u32 s9, s9, 65536
    buffer_load_dwordx4 v[60:63], v116, s[72:75], s9 offen nt
    s_add_u32 s9, s9, 65536
    buffer_load_dwordx4 v[64:67], v116, s[72:75], s9 offen nt
    s_add_u32 s9, s9, 65536
    buffer_load_dwordx4 v[68:71], v116, s[72:75], s9 offen nt
    s_add_u32 s9, s9, 65536
    buffer_load_dwordx4 v[72:75], v116, s[72:75], s9 offen nt
    s_add_u32 s9, s9, 65536
    buffer_load_dwordx4 v[76:79], v116, s[72:75], s9 offen nt
    s_add_u32 s9, s9, 65536
    buffer_load_dwordx4 v[80:83], v116, s[72:75], s9 offen nt
    s_add_u32 s9, s9, 65536
    buffer_load_dwordx4 v[84:87], v116, s[72:75], s9 offen nt
    s_add_u32 s9, s9, 65536
    buffer_load_dwordx4 v[88:91], v116, s[72:75], s9 offen nt
    s_add_u32 s9, s9, 65536
    buffer_load_dwordx4 v[92:95], v116, s[72:75], s9 offen nt
    s_add_u32 s9, s9, 65536
    buffer_load_dwordx4 v[96:99], v116, s[72:75], s9 offen nt
    s_add_u32 s9, s9, 65536
    buffer_load_dwordx4 v[100:103], v116, s[72:75], s9 offen nt
    s_branch L_w0b
L_h:
    s_cmp_eq_u32 s3, 1
    s_cbranch_scc1 L_h1
    s_cmp_ge_u32 s2, 16
    s_cbranch_scc1 L_nopf
    s_getpc_b64 s[10:11]
L_pc:
    s_sub_u32 s10, s10, L_pc-parallel_sum__sliding_block_cached__mixer_channel_mlp__decode_kernel
    s_subb_u32 s11, s11, 0
    v_lshlrev_b32 v3, 4, v1
    s_mov_b32 s12, 0
L_pf:
    global_load_dwordx4 v[4:7], v3, s[10:11]
    v_add_u32 v3, 1024, v3
    s_add_u32 s12, s12, 1024
    s_cmp_lt_u32 s12, L_end-parallel_sum__sliding_block_cached__mixer_channel_mlp__decode_kernel-1024
    s_cbranch_scc1 L_pf
L_nopf:
    s_barrier
    s_endpgm
L_h1:
    s_mov_b32 s80, s48
    s_and_b32 s81, s49, 0xffff
    s_mov_b32 s82, 5308416
    s_mov_b32 s83, 0x20000
    v_lshlrev_b32 v3, 4, v1
    global_load_dwordx4 v[4:7], v3, s[36:37]
    v_lshlrev_b32 v9, 1, v1
    global_load_ushort v8, v9, s[36:37] offset:1024
    v_mul_u32_u24 v140, 3641, v1
    v_lshrrev_b32 v140, 16, v140
    v_mul_u32_u24 v141, 18, v140
    v_sub_u32 v141, v1, v141
    s_movk_i32 s12, 9216
    v_mul_lo_u32 v142, v140, s12
    v_lshl_add_u32 v142, v141, 4, v142
    v_mov_b32 v2, 1073741824
    v_cmp_gt_u32 vcc, 54, v1
    s_nop 1
    v_cndmask_b32 v142, v2, v142, vcc
    s_and_b32 s8, s5, 7
    s_mul_i32 s8, s8, 72
    s_mul_i32 s9, s8, 9216
    s_mul_i32 s10, s4, 576
    s_add_u32 s9, s9, s10
    s_lshr_b32 s10, s5, 3
    s_mul_i32 s10, s10, 288
    s_add_u32 s9, s9, s10
    s_mov_b32 s18, s9
    buffer_load_dwordx4 v[32:35], v142, s[80:83], s18 offen nt
    s_add_u32 s18, s18, 27648
    buffer_load_dwordx4 v[36:39], v142, s[80:83], s18 offen nt
    s_add_u32 s18, s18, 27648
    buffer_load_dwordx4 v[40:43], v142, s[80:83], s18 offen nt
    s_add_u32 s18, s18, 27648
    buffer_load_dwordx4 v[44:47], v142, s[80:83], s18 offen nt
    s_add_u32 s18, s18, 27648
    buffer_load_dwordx4 v[48:51], v142, s[80:83], s18 offen nt
    s_add_u32 s18, s18, 27648
    buffer_load_dwordx4 v[52:55], v142, s[80:83], s18 offen nt
    s_add_u32 s18, s18, 27648
    buffer_load_dwordx4 v[56:59], v142, s[80:83], s18 offen nt
    s_add_u32 s18, s18, 27648
    buffer_load_dwordx4 v[60:63], v142, s[80:83], s18 offen nt
    s_add_u32 s18, s18, 27648
    buffer_load_dwordx4 v[64:67], v142, s[80:83], s18 offen nt
    s_add_u32 s18, s18, 27648
    buffer_load_dwordx4 v[68:71], v142, s[80:83], s18 offen nt
    s_add_u32 s18, s18, 27648
    buffer_load_dwordx4 v[72:75], v142, s[80:83], s18 offen nt
    s_add_u32 s18, s18, 27648
    buffer_load_dwordx4 v[76:79], v142, s[80:83], s18 offen nt
    s_add_u32 s18, s18, 27648
    buffer_load_dwordx4 v[80:83], v142, s[80:83], s18 offen nt
    s_add_u32 s18, s18, 27648
    buffer_load_dwordx4 v[84:87], v142, s[80:83], s18 offen nt
    s_add_u32 s18, s18, 27648
    buffer_load_dwordx4 v[88:91], v142, s[80:83], s18 offen nt
    s_add_u32 s18, s18, 27648
    buffer_load_dwordx4 v[92:95], v142, s[80:83], s18 offen nt
    s_add_u32 s18, s18, 27648
    buffer_load_dwordx4 v[96:99], v142, s[80:83], s18 offen nt
    s_add_u32 s18, s18, 27648
    buffer_load_dwordx4 v[100:103], v142, s[80:83], s18 offen nt
    s_add_u32 s18, s18, 27648
    buffer_load_dwordx4 v[104:107], v142, s[80:83], s18 offen nt
    s_add_u32 s18, s18, 27648
    buffer_load_dwordx4 v[108:111], v142, s[80:83], s18 offen nt
    s_add_u32 s18, s18, 27648
    buffer_load_dwordx4 v[112:115], v142, s[80:83], s18 offen nt
    s_add_u32 s18, s18, 27648
    buffer_load_dwordx4 v[116:119], v142, s[80:83], s18 offen nt
    s_add_u32 s18, s18, 27648
    buffer_load_dwordx4 v[120:123], v142, s[80:83], s18 offen nt
    s_add_u32 s18, s18, 27648
    buffer_load_dwordx4 v[124:127], v142, s[80:83], s18 offen nt
    s_branch L_w1b
L_sync:
    s_memrealtime s[16:17]
    s_and_b32 s9, s4, 3
    s_lshl_b32 s9, s9, 6
    s_lshr_b32 s10, s4, 2
    s_lshl_b32 s10, s10, 3
    s_add_u32 s9, s9, s10
    v_mov_b32 v2, s9
    v_mov_b32 v6, 0
    v_mov_b32 v7, 0
    v_mov_b32 v8, 0
    v_mov_b32 v9, 0
    v_mov_b32 v10, 0
    v_mov_b32 v11, 0
    v_mov_b32 v12, 3072
    s_waitcnt lgkmcnt(0)
    s_or_b32 s16, s16, 1
    v_mov_b32 v4, s16
    v_mov_b32 v5, s17
    v_cmp_eq_u32 vcc, 0, v1
    s_and_saveexec_b64 s[20:21], vcc
    global_atomic_cmpswap_x2 v[14:15], v2, v[4:7], s[58:59] sc0
    s_mov_b64 exec, s[20:21]
    ds_write_b128 v12, v[8:11]
    ds_write_b128 v12, v[8:11] offset:16
    s_waitcnt lgkmcnt(0)
    s_branch L_w2b
L_kvb:
    s_mov_b32 s68, s40
    s_and_b32 s69, s41, 0xffff
    s_mov_b32 s70, 268435456
    s_mov_b32 s71, 0x20000
    s_mov_b32 s76, s44
    s_and_b32 s77, s45, 0xffff
    s_mov_b32 s78, 4718592
    s_mov_b32 s79, 0x20000
    s_mov_b32 s84, s52
    s_and_b32 s85, s53, 0xffff
    s_mov_b32 s86, 5308416
    s_mov_b32 s87, 0x20000
    s_barrier
    s_cmp_lg_u32 s14, 0
    s_cbranch_scc1 L_thr_1
    ds_read_b32 v9, v8
    s_waitcnt lgkmcnt(0)
    s_nop 0
    v_readfirstlane_b32 s14, v9
    s_cmp_lg_u32 s14, 0
    s_cbranch_scc1 L_thr_1
    s_waitcnt vmcnt(2)
L_thr_1:
    buffer_load_dwordx4 v[28:31], v12, s[64:67], s9 offen offset:768 nt
    s_cmp_lg_u32 s14, 0
    s_cbranch_scc1 L_thr_2
    ds_read_b32 v9, v8
    s_waitcnt lgkmcnt(0)
    s_nop 0
    v_readfirstlane_b32 s14, v9
    s_cmp_lg_u32 s14, 0
    s_cbranch_scc1 L_thr_2
    s_waitcnt vmcnt(2)
L_thr_2:
    buffer_load_dwordx4 v[32:35], v12, s[64:67], s9 offen offset:1024 nt
    s_cmp_lg_u32 s14, 0
    s_cbranch_scc1 L_thr_3
    ds_read_b32 v9, v8
    s_waitcnt lgkmcnt(0)
    s_nop 0
    v_readfirstlane_b32 s14, v9
    s_cmp_lg_u32 s14, 0
    s_cbranch_scc1 L_thr_3
    s_waitcnt vmcnt(2)
L_thr_3:
    buffer_load_dwordx4 v[36:39], v12, s[64:67], s9 offen offset:1280 nt
    s_cmp_lg_u32 s14, 0
    s_cbranch_scc1 L_thr_4
    ds_read_b32 v9, v8
    s_waitcnt lgkmcnt(0)
    s_nop 0
    v_readfirstlane_b32 s14, v9
    s_cmp_lg_u32 s14, 0
    s_cbranch_scc1 L_thr_4
    s_waitcnt vmcnt(2)
L_thr_4:
    buffer_load_dwordx4 v[40:43], v12, s[64:67], s9 offen offset:1536 nt
    s_cmp_lg_u32 s14, 0
    s_cbranch_scc1 L_thr_5
    ds_read_b32 v9, v8
    s_waitcnt lgkmcnt(0)
    s_nop 0
    v_readfirstlane_b32 s14, v9
    s_cmp_lg_u32 s14, 0
    s_cbranch_scc1 L_thr_5
    s_waitcnt vmcnt(2)
L_thr_5:
    buffer_load_dwordx4 v[44:47], v12, s[64:67], s9 offen offset:1792 nt
    s_cmp_lg_u32 s14, 0
    s_cbranch_scc1 L_thr_6
    ds_read_b32 v9, v8
    s_waitcnt lgkmcnt(0)
    s_nop 0
    v_readfirstlane_b32 s14, v9
    s_cmp_lg_u32 s14, 0
    s_cbranch_scc1 L_thr_6
    s_waitcnt vmcnt(2)
L_thr_6:
    buffer_load_dwordx4 v[48:51], v12, s[68:71], s9 offen offset:0 nt
    s_cmp_lg_u32 s14, 0
    s_cbranch_scc1 L_thr_7
    ds_read_b32 v9, v8
    s_waitcnt lgkmcnt(0)
    s_nop 0
    v_readfirstlane_b32 s14, v9
    s_cmp_lg_u32 s14, 0
    s_cbranch_scc1 L_thr_7
    s_waitcnt vmcnt(2)
L_thr_7:
    buffer_load_dwordx4 v[52:55], v12, s[68:71], s9 offen offset:256 nt
    s_cmp_lg_u32 s14, 0
    s_cbranch_scc1 L_thr_8
    ds_read_b32 v9, v8
    s_waitcnt lgkmcnt(0)
    s_nop 0
    v_readfirstlane_b32 s14, v9
    s_cmp_lg_u32 s14, 0
    s_cbranch_scc1 L_thr_8
    s_waitcnt vmcnt(2)
L_thr_8:
    buffer_load_dwordx4 v[56:59], v12, s[68:71], s9 offen offset:512 nt
    s_cmp_lg_u32 s14, 0
    s_cbranch_scc1 L_thr_9
    ds_read_b32 v9, v8
    s_waitcnt lgkmcnt(0)
    s_nop 0
    v_readfirstlane_b32 s14, v9
    s_cmp_lg_u32 s14, 0
    s_cbranch_scc1 L_thr_9
    s_waitcnt vmcnt(2)
L_thr_9:
    buffer_load_dwordx4 v[60:63], v12, s[68:71], s9 offen offset:768 nt
    s_cmp_lg_u32 s14, 0
    s_cbranch_scc1 L_thr_10
    ds_read_b32 v9, v8
    s_waitcnt lgkmcnt(0)
    s_nop 0
    v_readfirstlane_b32 s14, v9
    s_cmp_lg_u32 s14, 0
    s_cbranch_scc1 L_thr_10
    s_waitcnt vmcnt(2)
L_thr_10:
    buffer_load_dwordx4 v[64:67], v12, s[68:71], s9 offen offset:1024 nt
    s_cmp_lg_u32 s14, 0
    s_cbranch_scc1 L_thr_11
    ds_read_b32 v9, v8
    s_waitcnt lgkmcnt(0)
    s_nop 0
    v_readfirstlane_b32 s14, v9
    s_cmp_lg_u32 s14, 0
    s_cbranch_scc1 L_thr_11
    s_waitcnt vmcnt(2)
L_thr_11:
    buffer_load_dwordx4 v[68:71], v12, s[68:71], s9 offen offset:1280 nt
    s_cmp_lg_u32 s14, 0
    s_cbranch_scc1 L_thr_12
    ds_read_b32 v9, v8
    s_waitcnt lgkmcnt(0)
    s_nop 0
    v_readfirstlane_b32 s14, v9
    s_cmp_lg_u32 s14, 0
    s_cbranch_scc1 L_thr_12
    s_waitcnt vmcnt(2)
L_thr_12:
    buffer_load_dwordx4 v[72:75], v12, s[68:71], s9 offen offset:1536 nt
    s_cmp_lg_u32 s14, 0
    s_cbranch_scc1 L_thr_13
    ds_read_b32 v9, v8
    s_waitcnt lgkmcnt(0)
    s_nop 0
    v_readfirstlane_b32 s14, v9
    s_cmp_lg_u32 s14, 0
    s_cbranch_scc1 L_thr_13
    s_waitcnt vmcnt(2)
L_thr_13:
    buffer_load_dwordx4 v[76:79], v12, s[68:71], s9 offen offset:1792 nt
    v_cmp_eq_u32 s[28:29], 1, v11
    v_cmp_eq_u32 s[30:31], 2, v11
    v_cmp_eq_u32 s[32:33], 3, v11
    s_mov_b32 s27, 0x3db504f3
    s_mov_b32 s34, 0x05040100
    s_mov_b32 s35, 0x07060302
    v_mov_b32 v4, 3076
    s_mov_b32 s12, 0
L_spin_14:
    ds_read_b32 v5, v4
    s_add_u32 s12, s12, 1
    s_waitcnt lgkmcnt(0)
    v_cmp_ne_u32 vcc, 0, v5
    s_cmp_gt_u32 s12, 1600000
    s_cbranch_scc1 L_spind_15
    s_cbranch_vccnz L_spind_15
    s_sleep 2
    s_branch L_spin_14
L_spind_15:
    v_mov_b32 v4, 3088
    s_mov_b32 s12, 0
L_gn_16:
    ds_read_b64 v[6:7], v4
    s_add_u32 s12, s12, 1
    s_waitcnt lgkmcnt(0)
    v_cmp_ne_u32 vcc, 0, v6
    s_cmp_gt_u32 s12, 1600000
    s_cbranch_scc1 L_gnd_17
    s_cbranch_vccnz L_gnd_17
    s_sleep 1
    s_branch L_gn_16
L_gnd_17:
    v_readfirstlane_b32 s16, v6
    v_readfirstlane_b32 s17, v7
    s_nop 1
    v_lshlrev_b32 v4, 4, v10
    ds_read_b128 v[96:99], v4 offset:2432
    ds_read_b128 v[100:103], v4 offset:2688
    v_and_b32 v4, 1, v1
    v_cmp_eq_u32 s[18:19], 1, v4
    s_waitcnt lgkmcnt(0)
    s_waitcnt vmcnt(15)
    v_dot2_f32_bf16 v80, v16, v96, 0
    v_dot2_f32_bf16 v81, v16, v100, 0
    v_dot2_f32_bf16 v80, v17, v97, v80
    v_dot2_f32_bf16 v81, v17, v101, v81
    v_dot2_f32_bf16 v80, v18, v98, v80
    v_dot2_f32_bf16 v81, v18, v102, v81
    v_dot2_f32_bf16 v80, v19, v99, v80
    v_dot2_f32_bf16 v81, v19, v103, v81
    s_waitcnt vmcnt(14)
    v_dot2_f32_bf16 v82, v20, v96, 0
    v_dot2_f32_bf16 v83, v20, v100, 0
    v_dot2_f32_bf16 v82, v21, v97, v82
    v_dot2_f32_bf16 v83, v21, v101, v83
    v_dot2_f32_bf16 v82, v22, v98, v82
    v_dot2_f32_bf16 v83, v22, v102, v83
    v_dot2_f32_bf16 v82, v23, v99, v82
    v_dot2_f32_bf16 v83, v23, v103, v83
    s_waitcnt vmcnt(13)
    v_dot2_f32_bf16 v84, v24, v96, 0
    v_dot2_f32_bf16 v85, v24, v100, 0
    v_dot2_f32_bf16 v84, v25, v97, v84
    v_dot2_f32_bf16 v85, v25, v101, v85
    v_dot2_f32_bf16 v84, v26, v98, v84
    v_dot2_f32_bf16 v85, v26, v102, v85
    v_dot2_f32_bf16 v84, v27, v99, v84
    v_dot2_f32_bf16 v85, v27, v103, v85
    s_waitcnt vmcnt(12)
    v_dot2_f32_bf16 v86, v28, v96, 0
    v_dot2_f32_bf16 v87, v28, v100, 0
    v_dot2_f32_bf16 v86, v29, v97, v86
    v_dot2_f32_bf16 v87, v29, v101, v87
    v_dot2_f32_bf16 v86, v30, v98, v86
    v_dot2_f32_bf16 v87, v30, v102, v87
    v_dot2_f32_bf16 v86, v31, v99, v86
    v_dot2_f32_bf16 v87, v31, v103, v87
    s_waitcnt vmcnt(11)
    v_dot2_f32_bf16 v88, v32, v96, 0
    v_dot2_f32_bf16 v89, v32, v100, 0
    v_dot2_f32_bf16 v88, v33, v97, v88
    v_dot2_f32_bf16 v89, v33, v101, v89
    v_dot2_f32_bf16 v88, v34, v98, v88
    v_dot2_f32_bf16 v89, v34, v102, v89
    v_dot2_f32_bf16 v88, v35, v99, v88
    v_dot2_f32_bf16 v89, v35, v103, v89
    s_waitcnt vmcnt(10)
    v_dot2_f32_bf16 v90, v36, v96, 0
    v_dot2_f32_bf16 v91, v36, v100, 0
    v_dot2_f32_bf16 v90, v37, v97, v90
    v_dot2_f32_bf16 v91, v37, v101, v91
    v_dot2_f32_bf16 v90, v38, v98, v90
    v_dot2_f32_bf16 v91, v38, v102, v91
    v_dot2_f32_bf16 v90, v39, v99, v90
    v_dot2_f32_bf16 v91, v39, v103, v91
    s_waitcnt vmcnt(9)
    v_dot2_f32_bf16 v92, v40, v96, 0
    v_dot2_f32_bf16 v93, v40, v100, 0
    v_dot2_f32_bf16 v92, v41, v97, v92
    v_dot2_f32_bf16 v93, v41, v101, v93
    v_dot2_f32_bf16 v92, v42, v98, v92
    v_dot2_f32_bf16 v93, v42, v102, v93
    v_dot2_f32_bf16 v92, v43, v99, v92
    v_dot2_f32_bf16 v93, v43, v103, v93
    s_waitcnt vmcnt(8)
    v_dot2_f32_bf16 v94, v44, v96, 0
    v_dot2_f32_bf16 v95, v44, v100, 0
    v_dot2_f32_bf16 v94, v45, v97, v94
    v_dot2_f32_bf16 v95, v45, v101, v95
    v_dot2_f32_bf16 v94, v46, v98, v94
    v_dot2_f32_bf16 v95, v46, v102, v95
    v_dot2_f32_bf16 v94, v47, v99, v94
    v_dot2_f32_bf16 v95, v47, v103, v95
    s_nop 2
    s_nop 1
    v_add_f32_dpp v80, v80, v80 row_ror:8 row_mask:0xf bank_mask:0xf
    v_add_f32_dpp v81, v81, v81 row_ror:8 row_mask:0xf bank_mask:0xf
    v_add_f32_dpp v82, v82, v82 row_ror:8 row_mask:0xf bank_mask:0xf
    v_add_f32_dpp v83, v83, v83 row_ror:8 row_mask:0xf bank_mask:0xf
    v_add_f32_dpp v84, v84, v84 row_ror:8 row_mask:0xf bank_mask:0xf
    v_add_f32_dpp v85, v85, v85 row_ror:8 row_mask:0xf bank_mask:0xf
    v_add_f32_dpp v86, v86, v86 row_ror:8 row_mask:0xf bank_mask:0xf
    v_add_f32_dpp v87, v87, v87 row_ror:8 row_mask:0xf bank_mask:0xf
    v_add_f32_dpp v88, v88, v88 row_ror:8 row_mask:0xf bank_mask:0xf
    v_add_f32_dpp v89, v89, v89 row_ror:8 row_mask:0xf bank_mask:0xf
    v_add_f32_dpp v90, v90, v90 row_ror:8 row_mask:0xf bank_mask:0xf
    v_add_f32_dpp v91, v91, v91 row_ror:8 row_mask:0xf bank_mask:0xf
    v_add_f32_dpp v92, v92, v92 row_ror:8 row_mask:0xf bank_mask:0xf
    v_add_f32_dpp v93, v93, v93 row_ror:8 row_mask:0xf bank_mask:0xf
    v_add_f32_dpp v94, v94, v94 row_ror:8 row_mask:0xf bank_mask:0xf
    v_add_f32_dpp v95, v95, v95 row_ror:8 row_mask:0xf bank_mask:0xf
    s_nop 1
    v_add_f32_dpp v80, v80, v80 row_ror:4 row_mask:0xf bank_mask:0xf
    v_add_f32_dpp v81, v81, v81 row_ror:4 row_mask:0xf bank_mask:0xf
    v_add_f32_dpp v82, v82, v82 row_ror:4 row_mask:0xf bank_mask:0xf
    v_add_f32_dpp v83, v83, v83 row_ror:4 row_mask:0xf bank_mask:0xf
    v_add_f32_dpp v84, v84, v84 row_ror:4 row_mask:0xf bank_mask:0xf
    v_add_f32_dpp v85, v85, v85 row_ror:4 row_mask:0xf bank_mask:0xf
    v_add_f32_dpp v86, v86, v86 row_ror:4 row_mask:0xf bank_mask:0xf
    v_add_f32_dpp v87, v87, v87 row_ror:4 row_mask:0xf bank_mask:0xf
    v_add_f32_dpp v88, v88, v88 row_ror:4 row_mask:0xf bank_mask:0xf
    v_add_f32_dpp v89, v89, v89 row_ror:4 row_mask:0xf bank_mask:0xf
    v_add_f32_dpp v90, v90, v90 row_ror:4 row_mask:0xf bank_mask:0xf
    v_add_f32_dpp v91, v91, v91 row_ror:4 row_mask:0xf bank_mask:0xf
    v_add_f32_dpp v92, v92, v92 row_ror:4 row_mask:0xf bank_mask:0xf
    v_add_f32_dpp v93, v93, v93 row_ror:4 row_mask:0xf bank_mask:0xf
    v_add_f32_dpp v94, v94, v94 row_ror:4 row_mask:0xf bank_mask:0xf
    v_add_f32_dpp v95, v95, v95 row_ror:4 row_mask:0xf bank_mask:0xf
    s_nop 1
    v_add_f32_dpp v80, v80, v80 row_ror:2 row_mask:0xf bank_mask:0xf
    v_add_f32_dpp v81, v81, v81 row_ror:2 row_mask:0xf bank_mask:0xf
    v_add_f32_dpp v82, v82, v82 row_ror:2 row_mask:0xf bank_mask:0xf
    v_add_f32_dpp v83, v83, v83 row_ror:2 row_mask:0xf bank_mask:0xf
    v_add_f32_dpp v84, v84, v84 row_ror:2 row_mask:0xf bank_mask:0xf
    v_add_f32_dpp v85, v85, v85 row_ror:2 row_mask:0xf bank_mask:0xf
    v_add_f32_dpp v86, v86, v86 row_ror:2 row_mask:0xf bank_mask:0xf
    v_add_f32_dpp v87, v87, v87 row_ror:2 row_mask:0xf bank_mask:0xf
    v_add_f32_dpp v88, v88, v88 row_ror:2 row_mask:0xf bank_mask:0xf
    v_add_f32_dpp v89, v89, v89 row_ror:2 row_mask:0xf bank_mask:0xf
    v_add_f32_dpp v90, v90, v90 row_ror:2 row_mask:0xf bank_mask:0xf
    v_add_f32_dpp v91, v91, v91 row_ror:2 row_mask:0xf bank_mask:0xf
    v_add_f32_dpp v92, v92, v92 row_ror:2 row_mask:0xf bank_mask:0xf
    v_add_f32_dpp v93, v93, v93 row_ror:2 row_mask:0xf bank_mask:0xf
    v_add_f32_dpp v94, v94, v94 row_ror:2 row_mask:0xf bank_mask:0xf
    v_add_f32_dpp v95, v95, v95 row_ror:2 row_mask:0xf bank_mask:0xf
    s_nop 1
    v_add_f32_dpp v80, v80, v80 row_ror:1 row_mask:0xf bank_mask:0xf
    v_add_f32_dpp v81, v81, v81 row_ror:1 row_mask:0xf bank_mask:0xf
    v_add_f32_dpp v82, v82, v82 row_ror:1 row_mask:0xf bank_mask:0xf
    v_add_f32_dpp v83, v83, v83 row_ror:1 row_mask:0xf bank_mask:0xf
    v_add_f32_dpp v84, v84, v84 row_ror:1 row_mask:0xf bank_mask:0xf
    v_add_f32_dpp v85, v85, v85 row_ror:1 row_mask:0xf bank_mask:0xf
    v_add_f32_dpp v86, v86, v86 row_ror:1 row_mask:0xf bank_mask:0xf
    v_add_f32_dpp v87, v87, v87 row_ror:1 row_mask:0xf bank_mask:0xf
    v_add_f32_dpp v88, v88, v88 row_ror:1 row_mask:0xf bank_mask:0xf
    v_add_f32_dpp v89, v89, v89 row_ror:1 row_mask:0xf bank_mask:0xf
    v_add_f32_dpp v90, v90, v90 row_ror:1 row_mask:0xf bank_mask:0xf
    v_add_f32_dpp v91, v91, v91 row_ror:1 row_mask:0xf bank_mask:0xf
    v_add_f32_dpp v92, v92, v92 row_ror:1 row_mask:0xf bank_mask:0xf
    v_add_f32_dpp v93, v93, v93 row_ror:1 row_mask:0xf bank_mask:0xf
    v_add_f32_dpp v94, v94, v94 row_ror:1 row_mask:0xf bank_mask:0xf
    v_add_f32_dpp v95, v95, v95 row_ror:1 row_mask:0xf bank_mask:0xf
    v_cvt_pk_bf16_f32 v16, v80, v81
    v_cvt_pk_bf16_f32 v17, v82, v83
    v_cvt_pk_bf16_f32 v18, v84, v85
    v_cvt_pk_bf16_f32 v19, v86, v87
    v_cvt_pk_bf16_f32 v20, v88, v89
    v_cvt_pk_bf16_f32 v21, v90, v91
    v_cvt_pk_bf16_f32 v22, v92, v93
    v_cvt_pk_bf16_f32 v23, v94, v95
    v_lshlrev_b32 v80, 16, v16
    v_and_b32 v81, s25, v16
    v_lshlrev_b32 v82, 16, v17
    v_and_b32 v83, s25, v17
    v_lshlrev_b32 v84, 16, v18
    v_and_b32 v85, s25, v18
    v_lshlrev_b32 v86, 16, v19
    v_and_b32 v87, s25, v19
    v_lshlrev_b32 v88, 16, v20
    v_and_b32 v89, s25, v20
    v_lshlrev_b32 v90, 16, v21
    v_and_b32 v91, s25, v21
    v_lshlrev_b32 v92, 16, v22
    v_and_b32 v93, s25, v22
    v_lshlrev_b32 v94, 16, v23
    v_and_b32 v95, s25, v23
    v_mul_f32 v80, s27, v80
    v_mul_f32 v81, s27, v81
    v_mul_f32 v82, s27, v82
    v_mul_f32 v83, s27, v83
    v_mul_f32 v84, s27, v84
    v_mul_f32 v85, s27, v85
    v_mul_f32 v86, s27, v86
    v_mul_f32 v87, s27, v87
    v_mul_f32 v88, s27, v88
    v_mul_f32 v89, s27, v89
    v_mul_f32 v90, s27, v90
    v_mul_f32 v91, s27, v91
    v_mul_f32 v92, s27, v92
    v_mul_f32 v93, s27, v93
    v_mul_f32 v94, s27, v94
    v_mul_f32 v95, s27, v95
    v_cvt_pk_bf16_f32 v16, v80, v81
    v_cvt_pk_bf16_f32 v17, v82, v83
    v_cvt_pk_bf16_f32 v18, v84, v85
    v_cvt_pk_bf16_f32 v19, v86, v87
    v_cvt_pk_bf16_f32 v20, v88, v89
    v_cvt_pk_bf16_f32 v21, v90, v91
    v_cvt_pk_bf16_f32 v22, v92, v93
    v_cvt_pk_bf16_f32 v23, v94, v95
    v_lshlrev_b32 v80, 16, v16
    v_and_b32 v81, s25, v16
    v_lshlrev_b32 v82, 16, v17
    v_and_b32 v83, s25, v17
    v_lshlrev_b32 v84, 16, v18
    v_and_b32 v85, s25, v18
    v_lshlrev_b32 v86, 16, v19
    v_and_b32 v87, s25, v19
    v_lshlrev_b32 v88, 16, v20
    v_and_b32 v89, s25, v20
    v_lshlrev_b32 v90, 16, v21
    v_and_b32 v91, s25, v21
    v_lshlrev_b32 v92, 16, v22
    v_and_b32 v93, s25, v22
    v_lshlrev_b32 v94, 16, v23
    v_and_b32 v95, s25, v23
    v_max3_f32 v24, v80, v82, v84
    v_max3_f32 v25, v81, v83, v85
    v_max3_f32 v26, v86, v88, v90
    v_max3_f32 v27, v87, v89, v91
    v_max3_f32 v24, v24, v92, v94
    v_max3_f32 v25, v25, v93, v95
    v_max_f32 v24, v24, v26
    v_max_f32 v25, v25, v27
    v_mov_b32 v26, v24
    v_mov_b32 v27, v25
    s_nop 1
    v_permlane16_swap_b32 v24, v26
    v_permlane16_swap_b32 v25, v27
    s_nop 0
    v_max_f32 v24, v24, v26
    v_max_f32 v25, v25, v27
    v_mov_b32 v26, v24
    v_mov_b32 v27, v25
    s_nop 1
    v_permlane32_swap_b32 v24, v26
    v_permlane32_swap_b32 v25, v27
    s_nop 0
    v_max_f32 v24, v24, v26
    v_max_f32 v25, v25, v27
    v_sub_f32 v80, v80, v24
    v_sub_f32 v81, v81, v25
    v_sub_f32 v82, v82, v24
    v_sub_f32 v83, v83, v25
    v_sub_f32 v84, v84, v24
    v_sub_f32 v85, v85, v25
    v_sub_f32 v86, v86, v24
    v_sub_f32 v87, v87, v25
    v_sub_f32 v88, v88, v24
    v_sub_f32 v89, v89, v25
    v_sub_f32 v90, v90, v24
    v_sub_f32 v91, v91, v25
    v_sub_f32 v92, v92, v24
    v_sub_f32 v93, v93, v25
    v_sub_f32 v94, v94, v24
    v_sub_f32 v95, v95, v25
    v_mul_f32 v80, s24, v80
    v_mul_f32 v81, s24, v81
    v_mul_f32 v82, s24, v82
    v_mul_f32 v83, s24, v83
    v_mul_f32 v84, s24, v84
    v_mul_f32 v85, s24, v85
    v_mul_f32 v86, s24, v86
    v_mul_f32 v87, s24, v87
    v_mul_f32 v88, s24, v88
    v_mul_f32 v89, s24, v89
    v_mul_f32 v90, s24, v90
    v_mul_f32 v91, s24, v91
    v_mul_f32 v92, s24, v92
    v_mul_f32 v93, s24, v93
    v_mul_f32 v94, s24, v94
    v_mul_f32 v95, s24, v95
    v_exp_f32 v80, v80
    v_exp_f32 v81, v81
    v_exp_f32 v82, v82
    v_exp_f32 v83, v83
    v_exp_f32 v84, v84
    v_exp_f32 v85, v85
    v_exp_f32 v86, v86
    v_exp_f32 v87, v87
    v_exp_f32 v88, v88
    v_exp_f32 v89, v89
    v_exp_f32 v90, v90
    v_exp_f32 v91, v91
    v_exp_f32 v92, v92
    v_exp_f32 v93, v93
    v_exp_f32 v94, v94
    v_exp_f32 v95, v95
    s_nop 0
    v_add_f32 v28, v80, v82
    v_add_f32 v30, v84, v86
    v_add_f32 v29, v81, v83
    v_add_f32 v31, v85, v87
    v_add_f32 v32, v88, v90
    v_add_f32 v34, v92, v94
    v_add_f32 v33, v89, v91
    v_add_f32 v35, v93, v95
    v_add_f32 v28, v28, v30
    v_add_f32 v32, v32, v34
    v_add_f32 v29, v29, v31
    v_add_f32 v33, v33, v35
    v_add_f32 v28, v28, v32
    v_add_f32 v29, v29, v33
    v_cvt_pk_bf16_f32 v16, v80, v82
    v_cvt_pk_bf16_f32 v36, v81, v83
    v_cvt_pk_bf16_f32 v17, v84, v86
    v_cvt_pk_bf16_f32 v37, v85, v87
    v_cvt_pk_bf16_f32 v18, v88, v90
    v_cvt_pk_bf16_f32 v38, v89, v91
    v_cvt_pk_bf16_f32 v19, v92, v94
    v_cvt_pk_bf16_f32 v39, v93, v95
    v_cndmask_b32 v20, v16, v36, s[18:19]
    v_cndmask_b32 v21, v17, v37, s[18:19]
    v_cndmask_b32 v22, v18, v38, s[18:19]
    v_cndmask_b32 v23, v19, v39, s[18:19]
    v_mov_b32 v26, v28
    v_mov_b32 v27, v29
    s_nop 1
    v_permlane16_swap_b32 v28, v26
    v_permlane16_swap_b32 v29, v27
    s_nop 0
    v_add_f32 v28, v28, v26
    v_add_f32 v29, v29, v27
    v_mov_b32 v26, v28
    v_mov_b32 v27, v29
    s_nop 1
    v_permlane32_swap_b32 v28, v26
    v_permlane32_swap_b32 v29, v27
    s_nop 0
    v_add_f32 v28, v28, v26
    v_add_f32 v29, v29, v27
    s_waitcnt vmcnt(6)
    v_perm_b32 v80, v52, v48, s34
    v_perm_b32 v84, v52, v48, s35
    v_perm_b32 v88, v53, v49, s34
    v_perm_b32 v92, v53, v49, s35
    v_perm_b32 v96, v54, v50, s34
    v_perm_b32 v100, v54, v50, s35
    v_perm_b32 v104, v55, v51, s34
    v_perm_b32 v108, v55, v51, s35
    s_waitcnt vmcnt(4)
    v_perm_b32 v81, v60, v56, s34
    v_perm_b32 v85, v60, v56, s35
    v_perm_b32 v89, v61, v57, s34
    v_perm_b32 v93, v61, v57, s35
    v_perm_b32 v97, v62, v58, s34
    v_perm_b32 v101, v62, v58, s35
    v_perm_b32 v105, v63, v59, s34
    v_perm_b32 v109, v63, v59, s35
    s_waitcnt vmcnt(2)
    v_perm_b32 v82, v68, v64, s34
    v_perm_b32 v86, v68, v64, s35
    v_perm_b32 v90, v69, v65, s34
    v_perm_b32 v94, v69, v65, s35
    v_perm_b32 v98, v70, v66, s34
    v_perm_b32 v102, v70, v66, s35
    v_perm_b32 v106, v71, v67, s34
    v_perm_b32 v110, v71, v67, s35
    s_waitcnt vmcnt(0)
    v_subrev_u32 v13, 256, v0
    s_and_b32 s15, s2, 3
    s_cmp_eq_u32 s15, 3
    s_cselect_b32 s62, 24, 16
    s_cselect_b32 s63, 21, 32
    s_movk_i32 s12, 4096
    s_cselect_b32 s12, 2731, s12
    v_mul_lo_u32 v14, v13, s12
    v_lshrrev_b32 v14, 16, v14
    v_mul_lo_u32 v15, v14, s62
    v_sub_u32 v15, v13, v15
    v_mul_u32_u24 v4, 1152, v14
    v_lshl_add_u32 v4, v15, 4, v4
    v_mov_b32 v7, 1073741824
    v_cmp_gt_u32 vcc, s63, v14
    s_nop 1
    v_cndmask_b32 v4, v7, v4, vcc
    s_lshr_b32 s13, s2, 2
    s_lshl_b32 s15, s15, 8
    s_mul_i32 s11, s63, 1152
    s_mul_i32 s9, s13, 82944
    s_add_u32 s9, s9, s15
    v_mov_b32 v5, v14
    v_cmp_gt_u32 vcc, 72, v5
    s_nop 1
    v_cndmask_b32 v6, v7, v4, vcc
    buffer_load_dwordx4 v[128:131], v6, s[84:87], s9 offen nt
    s_add_u32 s9, s9, s11
    v_add_u32 v5, s63, v5
    v_cmp_gt_u32 vcc, 72, v5
    s_nop 1
    v_cndmask_b32 v6, v7, v4, vcc
    buffer_load_dwordx4 v[132:135], v6, s[84:87], s9 offen nt
    s_add_u32 s9, s9, s11
    v_add_u32 v5, s63, v5
    v_cmp_gt_u32 vcc, 72, v5
    s_nop 1
    v_cndmask_b32 v6, v7, v4, vcc
    buffer_load_dwordx4 v[136:139], v6, s[84:87], s9 offen nt
    s_add_u32 s9, s9, s11
    v_add_u32 v5, s63, v5
    v_cmp_gt_u32 vcc, 72, v5
    s_nop 1
    v_cndmask_b32 v6, v7, v4, vcc
    buffer_load_dwordx4 v[140:143], v6, s[84:87], s9 offen nt
    s_mul_i32 s9, s13, 73728
    s_add_u32 s9, s9, s15
    v_mov_b32 v5, v14
    v_cmp_gt_u32 vcc, 64, v5
    s_nop 1
    v_cndmask_b32 v6, v7, v4, vcc
    buffer_load_dwordx4 v[144:147], v6, s[76:79], s9 offen nt
    s_add_u32 s9, s9, s11
    v_add_u32 v5, s63, v5
    v_cmp_gt_u32 vcc, 64, v5
    s_nop 1
    v_cndmask_b32 v6, v7, v4, vcc
    buffer_load_dwordx4 v[148:151], v6, s[76:79], s9 offen nt
    s_add_u32 s9, s9, s11
    v_add_u32 v5, s63, v5
    v_cmp_gt_u32 vcc, 64, v5
    s_nop 1
    v_cndmask_b32 v6, v7, v4, vcc
    buffer_load_dwordx4 v[152:155], v6, s[76:79], s9 offen nt
    s_add_u32 s9, s9, s11
    v_add_u32 v5, s63, v5
    v_cmp_gt_u32 vcc, 64, v5
    s_nop 1
    v_cndmask_b32 v6, v7, v4, vcc
    buffer_load_dwordx4 v[156:159], v6, s[76:79], s9 offen nt
    s_min_u32 s13, s2, 71
    s_lshl_b32 s13, s13, 4
    v_and_b32 v6, 1, v1
    v_lshlrev_b32 v6, 3, v6
    v_add_u32 v164, s13, v6
    global_load_dwordx2 v[160:161], v164, s[36:37]
    global_load_dwordx2 v[162:163], v164, s[54:55]
    v_perm_b32 v83, v76, v72, s34
    v_perm_b32 v87, v76, v72, s35
    v_perm_b32 v91, v77, v73, s34
    v_perm_b32 v95, v77, v73, s35
    v_perm_b32 v99, v78, v74, s34
    v_perm_b32 v103, v78, v74, s35
    v_perm_b32 v107, v79, v75, s34
    v_perm_b32 v111, v79, v75, s35
    s_nop 1
    v_mfma_f32_16x16x32_bf16 v[48:51], v[20:23], v[80:83], 0
    v_mfma_f32_16x16x32_bf16 v[52:55], v[20:23], v[84:87], 0
    v_mfma_f32_16x16x32_bf16 v[56:59], v[20:23], v[88:91], 0
    v_mfma_f32_16x16x32_bf16 v[60:63], v[20:23], v[92:95], 0
    v_mfma_f32_16x16x32_bf16 v[64:67], v[20:23], v[96:99], 0
    v_mfma_f32_16x16x32_bf16 v[68:71], v[20:23], v[100:103], 0
    v_mfma_f32_16x16x32_bf16 v[72:75], v[20:23], v[104:107], 0
    v_mfma_f32_16x16x32_bf16 v[76:79], v[20:23], v[108:111], 0
    s_nop 7
    s_nop 1
    v_cndmask_b32 v32, v48, v64, s[28:29]
    v_cndmask_b32 v33, v52, v68, s[28:29]
    v_cndmask_b32 v34, v56, v72, s[28:29]
    v_cndmask_b32 v35, v60, v76, s[28:29]
    v_cndmask_b32 v32, v32, v49, s[30:31]
    v_cndmask_b32 v33, v33, v53, s[30:31]
    v_cndmask_b32 v34, v34, v57, s[30:31]
    v_cndmask_b32 v35, v35, v61, s[30:31]
    v_cndmask_b32 v32, v32, v65, s[32:33]
    v_cndmask_b32 v33, v33, v69, s[32:33]
    v_cndmask_b32 v34, v34, v73, s[32:33]
    v_cndmask_b32 v35, v35, v77, s[32:33]
    v_lshrrev_b32 v5, 1, v11
    v_lshlrev_b32 v5, 9, v5
    v_lshl_add_u32 v5, v10, 5, v5
    v_and_b32 v6, 1, v11
    v_lshl_add_u32 v5, v6, 4, v5
    s_lshl_b32 s11, s7, 10
    v_add_u32 v5, s11, v5
    ds_write_b128 v5, v[32:35] offset:5632
    v_mov_b32 v36, v24
    v_mov_b32 v37, v28
    v_mov_b32 v38, v25
    v_mov_b32 v39, v29
    s_lshl_b32 s11, s7, 4
    v_mov_b32 v6, s11
    ds_write_b128 v6, v[36:39] offset:3136
    v_mov_b32 v7, 1
    v_mov_b32 v6, 3072
    s_waitcnt lgkmcnt(0)
    v_cmp_eq_u32 vcc, 0, v1
    s_and_saveexec_b64 s[20:21], vcc
    ds_add_rtn_u32 v7, v6, v7
    s_waitcnt lgkmcnt(0)
    s_mov_b64 exec, s[20:21]
    s_nop 0
    v_readfirstlane_b32 s11, v7
    s_cmp_lg_u32 s11, 7
    s_cbranch_scc1 L_kv_done
    v_mov_b32 v6, 0
    ds_read_b128 v[16:19], v6 offset:3136
    ds_read_b128 v[20:23], v6 offset:3152
    ds_read_b128 v[24:27], v6 offset:3168
    ds_read_b128 v[28:31], v6 offset:3184
    ds_read_b128 v[32:35], v6 offset:3200
    ds_read_b128 v[36:39], v6 offset:3216
    ds_read_b128 v[40:43], v6 offset:3232
    ds_read_b128 v[44:47], v6 offset:3248
    v_lshlrev_b32 v5, 4, v1
    ds_read_b128 v[48:51], v5 offset:5632
    ds_read_b128 v[52:55], v5 offset:6656
    ds_read_b128 v[56:59], v5 offset:7680
    ds_read_b128 v[60:63], v5 offset:8704
    ds_read_b128 v[64:67], v5 offset:9728
    ds_read_b128 v[68:71], v5 offset:10752
    ds_read_b128 v[72:75], v5 offset:11776
    ds_read_b128 v[76:79], v5 offset:12800
    v_cmp_gt_u32 vcc, 32, v1
    s_waitcnt lgkmcnt(8)
    s_nop 0
    v_cndmask_b32 v80, v18, v16, vcc
    v_cndmask_b32 v88, v19, v17, vcc
    v_cndmask_b32 v81, v22, v20, vcc
    v_cndmask_b32 v89, v23, v21, vcc
    v_cndmask_b32 v82, v26, v24, vcc
    v_cndmask_b32 v90, v27, v25, vcc
    v_cndmask_b32 v83, v30, v28, vcc
    v_cndmask_b32 v91, v31, v29, vcc
    v_cndmask_b32 v84, v34, v32, vcc
    v_cndmask_b32 v92, v35, v33, vcc
    v_cndmask_b32 v85, v38, v36, vcc
    v_cndmask_b32 v93, v39, v37, vcc
    v_cndmask_b32 v86, v42, v40, vcc
    v_cndmask_b32 v94, v43, v41, vcc
    v_cndmask_b32 v87, v46, v44, vcc
    v_cndmask_b32 v95, v47, v45, vcc
    v_max3_f32 v8, v80, v81, v82
    v_max3_f32 v9, v83, v84, v85
    v_max3_f32 v8, v8, v86, v87
    v_max_f32 v8, v8, v9
    v_sub_f32 v80, v80, v8
    v_sub_f32 v81, v81, v8
    v_sub_f32 v82, v82, v8
    v_sub_f32 v83, v83, v8
    v_sub_f32 v84, v84, v8
    v_sub_f32 v85, v85, v8
    v_sub_f32 v86, v86, v8
    v_sub_f32 v87, v87, v8
    v_mul_f32 v80, s24, v80
    v_mul_f32 v81, s24, v81
    v_mul_f32 v82, s24, v82
    v_mul_f32 v83, s24, v83
    v_mul_f32 v84, s24, v84
    v_mul_f32 v85, s24, v85
    v_mul_f32 v86, s24, v86
    v_mul_f32 v87, s24, v87
    v_exp_f32 v80, v80
    v_exp_f32 v81, v81
    v_exp_f32 v82, v82
    v_exp_f32 v83, v83
    v_exp_f32 v84, v84
    v_exp_f32 v85, v85
    v_exp_f32 v86, v86
    v_exp_f32 v87, v87
    s_nop 0
    v_mul_f32 v9, v80, v88
    v_fmac_f32 v9, v81, v89
    v_fmac_f32 v9, v82, v90
    v_fmac_f32 v9, v83, v91
    v_fmac_f32 v9, v84, v92
    v_fmac_f32 v9, v85, v93
    v_fmac_f32 v9, v86, v94
    v_fmac_f32 v9, v87, v95
    s_waitcnt lgkmcnt(0)
    v_mul_f32 v96, v80, v48
    v_mul_f32 v97, v80, v49
    v_mul_f32 v98, v80, v50
    v_mul_f32 v99, v80, v51
    v_fmac_f32 v96, v81, v52
    v_fmac_f32 v97, v81, v53
    v_fmac_f32 v98, v81, v54
    v_fmac_f32 v99, v81, v55
    v_fmac_f32 v96, v82, v56
    v_fmac_f32 v97, v82, v57
    v_fmac_f32 v98, v82, v58
    v_fmac_f32 v99, v82, v59
    v_fmac_f32 v96, v83, v60
    v_fmac_f32 v97, v83, v61
    v_fmac_f32 v98, v83, v62
    v_fmac_f32 v99, v83, v63
    v_fmac_f32 v96, v84, v64
    v_fmac_f32 v97, v84, v65
    v_fmac_f32 v98, v84, v66
    v_fmac_f32 v99, v84, v67
    v_fmac_f32 v96, v85, v68
    v_fmac_f32 v97, v85, v69
    v_fmac_f32 v98, v85, v70
    v_fmac_f32 v99, v85, v71
    v_fmac_f32 v96, v86, v72
    v_fmac_f32 v97, v86, v73
    v_fmac_f32 v98, v86, v74
    v_fmac_f32 v99, v86, v75
    v_fmac_f32 v96, v87, v76
    v_fmac_f32 v97, v87, v77
    v_fmac_f32 v98, v87, v78
    v_fmac_f32 v99, v87, v79
    v_mov_b32 v100, s16
    v_mov_b32 v101, v96
    v_mov_b32 v102, v97
    v_mov_b32 v103, s17
    v_mov_b32 v104, s16
    v_mov_b32 v105, v98
    v_mov_b32 v106, v99
    v_mov_b32 v107, s17
    v_mov_b32 v108, s16
    v_mov_b32 v109, v8
    v_mov_b32 v110, v9
    v_mov_b32 v111, s17
    s_lshl_b32 s11, s2, 12
    s_add_u32 s11, s11, 2097152
    buffer_store_dwordx4 v[100:103], v5, s[88:91], s11 offen sc1
    buffer_store_dwordx4 v[104:107], v5, s[88:91], s11 offen offset:1024 sc1
    v_lshrrev_b32 v6, 5, v1
    v_lshlrev_b32 v6, 4, v6
    v_and_b32 v7, 31, v1
    v_cmp_eq_u32 vcc, 0, v7
    s_and_saveexec_b64 s[20:21], vcc
    buffer_store_dwordx4 v[108:111], v6, s[88:91], s11 offen offset:2048 sc1
    s_mov_b64 exec, s[20:21]
    v_mov_b32 v6, 3084
    v_mov_b32 v7, 1
    ds_write_b32 v6, v7
    s_waitcnt lgkmcnt(0)
L_kv_done:
    v_mov_b32 v26, v14
    v_min_u32 v40, 95, v26
    v_lshlrev_b32 v40, 1, v40
    v_add_u32 v26, s63, v26
    v_min_u32 v41, 95, v26
    v_lshlrev_b32 v41, 1, v41
    v_add_u32 v26, s63, v26
    v_min_u32 v42, 95, v26
    v_lshlrev_b32 v42, 1, v42
    v_add_u32 v26, s63, v26
    v_min_u32 v43, 95, v26
    v_lshlrev_b32 v43, 1, v43
    s_lshl_b32 s9, s62, 6
    s_add_u32 s9, s9, 32
    v_mul_lo_u32 v27, v14, s9
    v_lshl_add_u32 v27, v15, 5, v27
    s_lshl_b32 s10, s62, 5
    v_add_u32 v28, s10, v27
    v_cmp_gt_u32 s[94:95], s63, v14
    v_mov_b32 v4, 3100
    s_mov_b32 s12, 0
L_spin_18:
    ds_read_b32 v5, v4
    s_add_u32 s12, s12, 1
    s_waitcnt lgkmcnt(0)
    v_cmp_ne_u32 vcc, 0, v5
    s_cmp_gt_u32 s12, 1600000
    s_cbranch_scc1 L_spind_19
    s_cbranch_vccnz L_spind_19
    s_sleep 1
    s_branch L_spin_18
L_spind_19:
    ds_read_u16 v16, v40 offset:4992
    ds_read_u16 v17, v41 offset:4992
    ds_read_u16 v18, v42 offset:4992
    ds_read_u16 v19, v43 offset:4992
    s_waitcnt lgkmcnt(0)
    v_lshlrev_b32 v32, 16, v16
    v_lshlrev_b32 v33, 16, v17
    v_lshlrev_b32 v34, 16, v18
    v_lshlrev_b32 v35, 16, v19
    s_waitcnt vmcnt(6)
    v_dot2_f32_bf16 v48, v128, v16, 0
    v_dot2_f32_bf16 v49, v128, v32, 0
    v_dot2_f32_bf16 v50, v129, v16, 0
    v_dot2_f32_bf16 v51, v129, v32, 0
    v_dot2_f32_bf16 v52, v130, v16, 0
    v_dot2_f32_bf16 v53, v130, v32, 0
    v_dot2_f32_bf16 v54, v131, v16, 0
    v_dot2_f32_bf16 v55, v131, v32, 0
    v_dot2_f32_bf16 v48, v132, v17, v48
    v_dot2_f32_bf16 v49, v132, v33, v49
    v_dot2_f32_bf16 v50, v133, v17, v50
    v_dot2_f32_bf16 v51, v133, v33, v51
    v_dot2_f32_bf16 v52, v134, v17, v52
    v_dot2_f32_bf16 v53, v134, v33, v53
    v_dot2_f32_bf16 v54, v135, v17, v54
    v_dot2_f32_bf16 v55, v135, v33, v55
    v_dot2_f32_bf16 v48, v136, v18, v48
    v_dot2_f32_bf16 v49, v136, v34, v49
    v_dot2_f32_bf16 v50, v137, v18, v50
    v_dot2_f32_bf16 v51, v137, v34, v51
    v_dot2_f32_bf16 v52, v138, v18, v52
    v_dot2_f32_bf16 v53, v138, v34, v53
    v_dot2_f32_bf16 v54, v139, v18, v54
    v_dot2_f32_bf16 v55, v139, v34, v55
    v_dot2_f32_bf16 v48, v140, v19, v48
    v_dot2_f32_bf16 v49, v140, v35, v49
    v_dot2_f32_bf16 v50, v141, v19, v50
    v_dot2_f32_bf16 v51, v141, v35, v51
    v_dot2_f32_bf16 v52, v142, v19, v52
    v_dot2_f32_bf16 v53, v142, v35, v53
    v_dot2_f32_bf16 v54, v143, v19, v54
    v_dot2_f32_bf16 v55, v143, v35, v55
    s_nop 2
    s_and_saveexec_b64 s[22:23], s[94:95]
    ds_write_b128 v28, v[48:51] offset:13824
    ds_write_b128 v28, v[52:55] offset:13840
    s_mov_b64 exec, s[22:23]
    s_waitcnt vmcnt(0)
    s_barrier
    ds_read_u16 v20, v40 offset:5184
    ds_read_u16 v21, v41 offset:5184
    ds_read_u16 v22, v42 offset:5184
    ds_read_u16 v23, v43 offset:5184
    s_waitcnt lgkmcnt(0)
    v_lshlrev_b32 v36, 16, v20
    v_lshlrev_b32 v37, 16, v21
    v_lshlrev_b32 v38, 16, v22
    v_lshlrev_b32 v39, 16, v23
    v_dot2_f32_bf16 v56, v144, v20, 0
    v_dot2_f32_bf16 v57, v144, v36, 0
    v_dot2_f32_bf16 v58, v145, v20, 0
    v_dot2_f32_bf16 v59, v145, v36, 0
    v_dot2_f32_bf16 v60, v146, v20, 0
    v_dot2_f32_bf16 v61, v146, v36, 0
    v_dot2_f32_bf16 v62, v147, v20, 0
    v_dot2_f32_bf16 v63, v147, v36, 0
    v_dot2_f32_bf16 v56, v148, v21, v56
    v_dot2_f32_bf16 v57, v148, v37, v57
    v_dot2_f32_bf16 v58, v149, v21, v58
    v_dot2_f32_bf16 v59, v149, v37, v59
    v_dot2_f32_bf16 v60, v150, v21, v60
    v_dot2_f32_bf16 v61, v150, v37, v61
    v_dot2_f32_bf16 v62, v151, v21, v62
    v_dot2_f32_bf16 v63, v151, v37, v63
    v_dot2_f32_bf16 v56, v152, v22, v56
    v_dot2_f32_bf16 v57, v152, v38, v57
    v_dot2_f32_bf16 v58, v153, v22, v58
    v_dot2_f32_bf16 v59, v153, v38, v59
    v_dot2_f32_bf16 v60, v154, v22, v60
    v_dot2_f32_bf16 v61, v154, v38, v61
    v_dot2_f32_bf16 v62, v155, v22, v62
    v_dot2_f32_bf16 v63, v155, v38, v63
    v_dot2_f32_bf16 v56, v156, v23, v56
    v_dot2_f32_bf16 v57, v156, v39, v57
    v_dot2_f32_bf16 v58, v157, v23, v58
    v_dot2_f32_bf16 v59, v157, v39, v59
    v_dot2_f32_bf16 v60, v158, v23, v60
    v_dot2_f32_bf16 v61, v158, v39, v61
    v_dot2_f32_bf16 v62, v159, v23, v62
    v_dot2_f32_bf16 v63, v159, v39, v63
    s_nop 2
    s_and_saveexec_b64 s[22:23], s[94:95]
    ds_write_b128 v27, v[56:59] offset:13824
    ds_write_b128 v27, v[60:63] offset:13840
    s_mov_b64 exec, s[22:23]
    s_waitcnt lgkmcnt(0)
    s_barrier
    s_cmp_eq_u32 s62, 24
    s_cbranch_scc1 L_wide
    v_cmp_gt_u32 vcc, 512, v13
    s_and_saveexec_b64 s[20:21], vcc
    s_cbranch_execz L_p3skip
    v_lshrrev_b32 v4, 2, v13
    v_lshrrev_b32 v5, 3, v4
    v_lshlrev_b32 v5, 5, v5
    v_and_b32 v6, 1, v4
    v_lshl_add_u32 v5, v6, 4, v5
    v_bfe_u32 v6, v4, 1, 1
    v_lshl_add_u32 v5, v6, 3, v5
    v_bfe_u32 v6, v4, 2, 1
    v_mul_u32_u24 v6, 512, v6
    v_add_u32 v5, v5, v6
    v_and_b32 v6, 3, v13
    v_mul_u32_u24 v7, 8448, v6
    v_add_u32 v8, v5, v7
    ds_read_b64 v[32:33], v8 offset:13824
    ds_read_b64 v[34:35], v8 offset:14880
    ds_read_b64 v[36:37], v8 offset:15936
    ds_read_b64 v[38:39], v8 offset:16992
    ds_read_b64 v[40:41], v8 offset:18048
    ds_read_b64 v[42:43], v8 offset:19104
    ds_read_b64 v[44:45], v8 offset:20160
    ds_read_b64 v[46:47], v8 offset:21216
    s_waitcnt lgkmcnt(0)
    v_add_f32 v32, v32, v46
    v_add_f32 v33, v33, v47
    v_add_f32 v34, v34, v44
    v_add_f32 v35, v35, v45
    v_add_f32 v36, v36, v42
    v_add_f32 v37, v37, v43
    v_add_f32 v38, v38, v40
    v_add_f32 v39, v39, v41
    v_add_f32 v32, v32, v38
    v_add_f32 v33, v33, v39
    v_add_f32 v34, v34, v36
    v_add_f32 v35, v35, v37
    v_add_f32 v32, v32, v34
    v_add_f32 v33, v33, v35
    s_nop 1
    v_add_f32_dpp v32, v32, v32 quad_perm:[1,0,3,2] row_mask:0xf bank_mask:0xf
    v_add_f32_dpp v33, v33, v33 quad_perm:[1,0,3,2] row_mask:0xf bank_mask:0xf
    s_nop 1
    v_add_f32_dpp v32, v32, v32 quad_perm:[2,3,0,1] row_mask:0xf bank_mask:0xf
    v_add_f32_dpp v33, v33, v33 quad_perm:[2,3,0,1] row_mask:0xf bank_mask:0xf
    v_mov_b32 v64, s16
    v_mov_b32 v65, v32
    v_mov_b32 v66, v33
    v_mov_b32 v67, s17
    s_lshl_b32 s9, s2, 12
    s_add_u32 s9, s9, 4194304
    v_lshlrev_b32 v3, 4, v4
    v_cmp_eq_u32 vcc, 0, v6
    s_and_b64 exec, exec, vcc
    buffer_store_dwordx4 v[64:67], v3, s[88:91], s9 offen sc1
    s_branch L_p3skip
L_wide:
    v_cmp_gt_u32 vcc, 384, v13
    s_and_saveexec_b64 s[20:21], vcc
    s_cbranch_execz L_p3skip
    v_lshrrev_b32 v4, 1, v13
    v_lshrrev_b32 v5, 3, v4
    v_lshlrev_b32 v5, 5, v5
    v_and_b32 v6, 1, v4
    v_lshl_add_u32 v5, v6, 4, v5
    v_bfe_u32 v6, v4, 1, 1
    v_lshl_add_u32 v5, v6, 3, v5
    v_bfe_u32 v6, v4, 2, 1
    v_mul_u32_u24 v6, 768, v6
    v_add_u32 v5, v5, v6
    v_and_b32 v6, 1, v13
    v_mul_u32_u24 v7, 17248, v6
    v_add_u32 v8, v5, v7
    ds_read_b64 v[32:33], v8 offset:13824
    ds_read_b64 v[34:35], v8 offset:15392
    ds_read_b64 v[36:37], v8 offset:16960
    ds_read_b64 v[38:39], v8 offset:18528
    ds_read_b64 v[40:41], v8 offset:20096
    ds_read_b64 v[42:43], v8 offset:21664
    ds_read_b64 v[44:45], v8 offset:23232
    ds_read_b64 v[46:47], v8 offset:24800
    ds_read_b64 v[48:49], v8 offset:26368
    ds_read_b64 v[50:51], v8 offset:27936
    v_mov_b32 v52, 0
    v_mov_b32 v53, 0
    v_cmp_eq_u32 vcc, 0, v6
    s_and_saveexec_b64 s[22:23], vcc
    ds_read_b64 v[52:53], v8 offset:29504
    s_mov_b64 exec, s[22:23]
    s_waitcnt lgkmcnt(0)
    v_add_f32 v32, v32, v52
    v_add_f32 v33, v33, v53
    v_add_f32 v34, v34, v50
    v_add_f32 v35, v35, v51
    v_add_f32 v36, v36, v48
    v_add_f32 v37, v37, v49
    v_add_f32 v38, v38, v46
    v_add_f32 v39, v39, v47
    v_add_f32 v40, v40, v44
    v_add_f32 v41, v41, v45
    v_add_f32 v32, v32, v42
    v_add_f32 v33, v33, v43
    v_add_f32 v34, v34, v40
    v_add_f32 v35, v35, v41
    v_add_f32 v36, v36, v38
    v_add_f32 v37, v37, v39
    v_add_f32 v32, v32, v36
    v_add_f32 v33, v33, v37
    v_add_f32 v32, v32, v34
    v_add_f32 v33, v33, v35
    s_nop 1
    v_add_f32_dpp v32, v32, v32 quad_perm:[1,0,3,2] row_mask:0xf bank_mask:0xf
    v_add_f32_dpp v33, v33, v33 quad_perm:[1,0,3,2] row_mask:0xf bank_mask:0xf
    v_mov_b32 v64, s16
    v_mov_b32 v65, v32
    v_mov_b32 v66, v33
    v_mov_b32 v67, s17
    s_lshl_b32 s9, s2, 12
    s_add_u32 s9, s9, 4194304
    v_lshlrev_b32 v3, 4, v4
    v_cmp_eq_u32 vcc, 0, v6
    s_and_b64 exec, exec, vcc
    buffer_store_dwordx4 v[64:67], v3, s[88:91], s9 offen sc1
L_p3skip:
    s_mov_b64 exec, s[20:21]
L_p3done:
    s_cmp_ge_u32 s2, 72
    s_cbranch_scc1 L_fdone
    v_mov_b32 v4, 3080
    s_mov_b32 s12, 0
L_spin_20:
    ds_read_b32 v5, v4
    s_add_u32 s12, s12, 1
    s_waitcnt lgkmcnt(0)
    v_cmp_ne_u32 vcc, 0, v5
    s_cmp_gt_u32 s12, 1600000
    s_cbranch_scc1 L_spind_21
    s_cbranch_vccnz L_spind_21
    s_sleep 1
    s_branch L_spin_20
L_spind_21:
    s_lshr_b32 s10, s2, 4
    s_min_u32 s10, s10, 3
    s_lshl_b32 s11, s10, 4
    s_sub_u32 s11, s2, s11
    v_lshrrev_b32 v4, 3, v13
    v_lshrrev_b32 v6, 2, v4
    v_lshlrev_b32 v6, 3, v6
    ds_read_b64 v[72:73], v6 offset:3264
    v_lshlrev_b32 v4, 14, v4
    v_and_b32 v5, 7, v13
    v_lshl_add_u32 v4, v5, 4, v4
    s_lshl_b32 s9, s10, 12
    s_lshl_b32 s11, s11, 7
    s_add_u32 s9, s9, s11
    s_add_u32 s9, s9, 4194304
    s_waitcnt lgkmcnt(0)
    s_mov_b32 s12, 0
L_poll_22:
    buffer_load_dwordx4 v[48:51], v4, s[88:91], s9 offen sc1
    s_add_u32 s12, s12, 1
    s_waitcnt vmcnt(0)
    v_xor_b32 v41, v72, v48
    v_xor_b32 v42, v73, v51
    v_or_b32 v40, v41, v42
    v_cmp_ne_u32 vcc, 0, v40
    s_cmp_gt_u32 s12, 400000
    s_cbranch_scc1 L_polld_23
    s_cbranch_vccz L_polld_23
    s_branch L_poll_22
L_polld_23:
    v_mov_b32 v32, v49
    v_mov_b32 v33, v50
    s_nop 1
    v_add_f32_dpp v32, v32, v32 row_ror:8 row_mask:0xf bank_mask:0xf
    v_add_f32_dpp v33, v33, v33 row_ror:8 row_mask:0xf bank_mask:0xf
    v_mov_b32 v64, v32
    v_mov_b32 v65, v33
    s_nop 1
    v_permlane16_swap_b32 v32, v64
    v_permlane16_swap_b32 v33, v65
    s_nop 0
    v_add_f32 v32, v32, v64
    v_add_f32 v33, v33, v65
    v_mov_b32 v64, v32
    v_mov_b32 v65, v33
    s_nop 1
    v_permlane32_swap_b32 v32, v64
    v_permlane32_swap_b32 v33, v65
    s_nop 0
    v_add_f32 v32, v32, v64
    v_add_f32 v33, v33, v65
    s_lshl_b32 s9, s7, 6
    v_lshl_add_u32 v5, v1, 3, s9
    v_cmp_gt_u32 vcc, 8, v1
    s_and_saveexec_b64 s[20:21], vcc
    ds_write_b64 v5, v[32:33] offset:4480
    s_mov_b64 exec, s[20:21]
    s_waitcnt lgkmcnt(0)
    s_barrier
    s_cmp_lg_u32 s7, 0
    s_cbranch_scc1 L_fdone
    v_and_b32 v5, 1, v1
    v_lshlrev_b32 v5, 3, v5
    ds_read_b64 v[48:49], v5 offset:4480
    ds_read_b64 v[50:51], v5 offset:4496
    ds_read_b64 v[52:53], v5 offset:4512
    ds_read_b64 v[54:55], v5 offset:4528
    ds_read_b64 v[56:57], v5 offset:4544
    ds_read_b64 v[58:59], v5 offset:4560
    ds_read_b64 v[60:61], v5 offset:4576
    ds_read_b64 v[62:63], v5 offset:4592
    ds_read_b64 v[64:65], v5 offset:4608
    ds_read_b64 v[66:67], v5 offset:4624
    ds_read_b64 v[68:69], v5 offset:4640
    ds_read_b64 v[70:71], v5 offset:4656
    ds_read_b64 v[72:73], v5 offset:4672
    ds_read_b64 v[74:75], v5 offset:4688
    ds_read_b64 v[76:77], v5 offset:4704
    ds_read_b64 v[78:79], v5 offset:4720
    ds_read_b64 v[80:81], v5 offset:4736
    ds_read_b64 v[82:83], v5 offset:4752
    ds_read_b64 v[84:85], v5 offset:4768
    ds_read_b64 v[86:87], v5 offset:4784
    ds_read_b64 v[88:89], v5 offset:4800
    ds_read_b64 v[90:91], v5 offset:4816
    ds_read_b64 v[92:93], v5 offset:4832
    ds_read_b64 v[94:95], v5 offset:4848
    ds_read_b64 v[96:97], v5 offset:4864
    ds_read_b64 v[98:99], v5 offset:4880
    ds_read_b64 v[100:101], v5 offset:4896
    ds_read_b64 v[102:103], v5 offset:4912
    ds_read_b64 v[104:105], v5 offset:4928
    ds_read_b64 v[106:107], v5 offset:4944
    ds_read_b64 v[108:109], v5 offset:4960
    ds_read_b64 v[110:111], v5 offset:4976
    s_waitcnt lgkmcnt(15)
    v_add_f32 v48, v48, v56
    v_add_f32 v49, v49, v57
    v_add_f32 v50, v50, v58
    v_add_f32 v51, v51, v59
    v_add_f32 v52, v52, v60
    v_add_f32 v53, v53, v61
    v_add_f32 v54, v54, v62
    v_add_f32 v55, v55, v63
    s_waitcnt lgkmcnt(15)
    v_add_f32 v48, v48, v64
    v_add_f32 v49, v49, v65
    v_add_f32 v50, v50, v66
    v_add_f32 v51, v51, v67
    v_add_f32 v52, v52, v68
    v_add_f32 v53, v53, v69
    v_add_f32 v54, v54, v70
    v_add_f32 v55, v55, v71
    s_waitcnt lgkmcnt(15)
    v_add_f32 v48, v48, v72
    v_add_f32 v49, v49, v73
    v_add_f32 v50, v50, v74
    v_add_f32 v51, v51, v75
    v_add_f32 v52, v52, v76
    v_add_f32 v53, v53, v77
    v_add_f32 v54, v54, v78
    v_add_f32 v55, v55, v79
    s_waitcnt lgkmcnt(12)
    v_add_f32 v48, v48, v80
    v_add_f32 v49, v49, v81
    v_add_f32 v50, v50, v82
    v_add_f32 v51, v51, v83
    v_add_f32 v52, v52, v84
    v_add_f32 v53, v53, v85
    v_add_f32 v54, v54, v86
    v_add_f32 v55, v55, v87
    s_waitcnt lgkmcnt(8)
    v_add_f32 v48, v48, v88
    v_add_f32 v49, v49, v89
    v_add_f32 v50, v50, v90
    v_add_f32 v51, v51, v91
    v_add_f32 v52, v52, v92
    v_add_f32 v53, v53, v93
    v_add_f32 v54, v54, v94
    v_add_f32 v55, v55, v95
    s_waitcnt lgkmcnt(4)
    v_add_f32 v48, v48, v96
    v_add_f32 v49, v49, v97
    v_add_f32 v50, v50, v98
    v_add_f32 v51, v51, v99
    v_add_f32 v52, v52, v100
    v_add_f32 v53, v53, v101
    v_add_f32 v54, v54, v102
    v_add_f32 v55, v55, v103
    s_waitcnt lgkmcnt(0)
    v_add_f32 v48, v48, v104
    v_add_f32 v49, v49, v105
    v_add_f32 v50, v50, v106
    v_add_f32 v51, v51, v107
    v_add_f32 v52, v52, v108
    v_add_f32 v53, v53, v109
    v_add_f32 v54, v54, v110
    v_add_f32 v55, v55, v111
    v_mov_b32 v64, v52
    v_mov_b32 v65, v53
    v_mov_b32 v66, v54
    v_mov_b32 v67, v55
    v_cvt_pk_bf16_f32 v80, v48, v49
    v_cvt_pk_bf16_f32 v81, v50, v51
    v_lshlrev_b32 v48, 16, v80
    v_and_b32 v49, s25, v80
    v_lshlrev_b32 v50, 16, v81
    v_and_b32 v51, s25, v81
    v_cvt_pk_bf16_f32 v80, v64, v65
    v_cvt_pk_bf16_f32 v81, v66, v67
    v_lshlrev_b32 v64, 16, v80
    v_and_b32 v65, s25, v80
    v_lshlrev_b32 v66, 16, v81
    v_and_b32 v67, s25, v81
    v_lshlrev_b32 v52, 16, v160
    v_and_b32 v53, s25, v160
    v_lshlrev_b32 v54, 16, v161
    v_and_b32 v55, s25, v161
    v_lshlrev_b32 v56, 16, v162
    v_and_b32 v57, s25, v162
    v_lshlrev_b32 v58, 16, v163
    v_and_b32 v59, s25, v163
    v_add_f32 v48, v52, v48
    v_add_f32 v64, v64, v56
    v_add_f32 v49, v53, v49
    v_add_f32 v65, v65, v57
    v_add_f32 v50, v54, v50
    v_add_f32 v66, v66, v58
    v_add_f32 v51, v55, v51
    v_add_f32 v67, v67, v59
    v_cvt_pk_bf16_f32 v80, v48, v49
    v_cvt_pk_bf16_f32 v81, v50, v51
    v_lshlrev_b32 v48, 16, v80
    v_and_b32 v49, s25, v80
    v_lshlrev_b32 v50, 16, v81
    v_and_b32 v51, s25, v81
    v_cvt_pk_bf16_f32 v80, v64, v65
    v_cvt_pk_bf16_f32 v81, v66, v67
    v_lshlrev_b32 v64, 16, v80
    v_and_b32 v65, s25, v80
    v_lshlrev_b32 v66, 16, v81
    v_and_b32 v67, s25, v81
    v_add_f32 v48, v48, v64
    v_add_f32 v49, v49, v65
    v_add_f32 v50, v50, v66
    v_add_f32 v51, v51, v67
    v_cvt_pk_bf16_f32 v80, v48, v49
    v_cvt_pk_bf16_f32 v81, v50, v51
    v_cmp_gt_u32 vcc, 2, v1
    s_and_saveexec_b64 s[20:21], vcc
    global_store_dwordx2 v164, v[80:81], s[56:57]
    s_mov_b64 exec, s[20:21]
L_fdone:
    s_endpgm
L_w0b:
    s_barrier
    s_waitcnt vmcnt(18)
    v_lshlrev_b32 v10, 16, v4
    v_and_b32 v11, s25, v4
    v_lshlrev_b32 v12, 16, v5
    v_and_b32 v13, s25, v5
    v_lshlrev_b32 v14, 16, v6
    v_and_b32 v15, s25, v6
    v_lshlrev_b32 v16, 16, v7
    v_and_b32 v17, s25, v7
    v_lshlrev_b32 v18, 16, v8
    v_add_f32 v104, v10, v11
    v_add_f32 v105, v12, v13
    v_add_f32 v106, v14, v15
    v_add_f32 v107, v16, v17
    v_add_f32 v104, v104, v105
    v_add_f32 v106, v106, v107
    v_add_f32 v104, v104, v18
    v_add_f32 v104, v104, v106
    s_nop 1
    v_add_f32_dpp v104, v104, v104 row_ror:8 row_mask:0xf bank_mask:0xf
    s_nop 1
    v_add_f32_dpp v104, v104, v104 row_ror:4 row_mask:0xf bank_mask:0xf
    s_nop 1
    v_add_f32_dpp v104, v104, v104 row_ror:2 row_mask:0xf bank_mask:0xf
    s_nop 1
    v_add_f32_dpp v104, v104, v104 row_ror:1 row_mask:0xf bank_mask:0xf
    v_mov_b32 v105, v104
    s_nop 1
    v_permlane16_swap_b32 v104, v105
    s_nop 0
    v_add_f32 v104, v104, v105
    v_mov_b32 v105, v104
    s_nop 1
    v_permlane32_swap_b32 v104, v105
    s_nop 0
    v_add_f32 v104, v104, v105
    v_mul_f32 v104, 0x3ae38e39, v104
    v_sub_f32 v20, v10, v104
    v_sub_f32 v21, v11, v104
    v_sub_f32 v22, v12, v104
    v_sub_f32 v23, v13, v104
    v_sub_f32 v24, v14, v104
    v_sub_f32 v25, v15, v104
    v_sub_f32 v26, v16, v104
    v_sub_f32 v27, v17, v104
    v_sub_f32 v28, v18, v104
    v_mul_f32 v106, v20, v20
    v_mul_f32 v107, v21, v21
    v_mul_f32 v108, v22, v22
    v_fmac_f32 v106, v23, v23
    v_fmac_f32 v107, v24, v24
    v_fmac_f32 v108, v25, v25
    v_fmac_f32 v106, v26, v26
    v_fmac_f32 v107, v27, v27
    v_fmac_f32 v108, v28, v28
    v_add_f32 v106, v106, v107
    v_add_f32 v106, v106, v108
    s_nop 1
    v_add_f32_dpp v106, v106, v106 row_ror:8 row_mask:0xf bank_mask:0xf
    s_nop 1
    v_add_f32_dpp v106, v106, v106 row_ror:4 row_mask:0xf bank_mask:0xf
    s_nop 1
    v_add_f32_dpp v106, v106, v106 row_ror:2 row_mask:0xf bank_mask:0xf
    s_nop 1
    v_add_f32_dpp v106, v106, v106 row_ror:1 row_mask:0xf bank_mask:0xf
    v_mov_b32 v105, v106
    s_nop 1
    v_permlane16_swap_b32 v106, v105
    s_nop 0
    v_add_f32 v106, v106, v105
    v_mov_b32 v105, v106
    s_nop 1
    v_permlane32_swap_b32 v106, v105
    s_nop 0
    v_add_f32 v106, v106, v105
    v_mul_f32 v106, 0x3ae38e39, v106
    v_cvt_pk_bf16_f32 v105, v104, v106
    v_lshlrev_b32 v104, 16, v105
    v_and_b32 v106, s25, v105
    v_add_f32 v106, 0x3727c5ac, v106
    v_cvt_pk_bf16_f32 v106, v106, v106
    v_and_b32 v106, s25, v106
    v_sqrt_f32 v106, v106
    s_nop 0
    v_cvt_pk_bf16_f32 v106, v106, v106
    v_and_b32 v106, s25, v106
    v_rcp_f32 v107, v106
    v_sub_f32 v20, v10, v104
    v_sub_f32 v21, v11, v104
    v_sub_f32 v22, v12, v104
    v_sub_f32 v23, v13, v104
    v_sub_f32 v24, v14, v104
    v_sub_f32 v25, v15, v104
    v_sub_f32 v26, v16, v104
    v_sub_f32 v27, v17, v104
    v_sub_f32 v28, v18, v104
    v_cvt_pk_bf16_f32 v108, v20, v21
    v_cvt_pk_bf16_f32 v109, v22, v23
    v_cvt_pk_bf16_f32 v110, v24, v25
    v_cvt_pk_bf16_f32 v111, v26, v27
    v_cvt_pk_bf16_f32 v112, v28, v28
    v_lshlrev_b32 v20, 16, v108
    v_and_b32 v21, s25, v108
    v_lshlrev_b32 v22, 16, v109
    v_and_b32 v23, s25, v109
    v_lshlrev_b32 v24, 16, v110
    v_and_b32 v25, s25, v110
    v_lshlrev_b32 v26, 16, v111
    v_and_b32 v27, s25, v111
    v_lshlrev_b32 v28, 16, v112
    v_mul_f32 v10, v20, v107
    v_mul_f32 v11, v21, v107
    v_mul_f32 v12, v22, v107
    v_mul_f32 v13, v23, v107
    v_mul_f32 v14, v24, v107
    v_mul_f32 v15, v25, v107
    v_mul_f32 v16, v26, v107
    v_mul_f32 v17, v27, v107
    v_mul_f32 v18, v28, v107
    v_fma_f32 v20, -v10, v106, v20
    v_fma_f32 v21, -v11, v106, v21
    v_fma_f32 v22, -v12, v106, v22
    v_fma_f32 v23, -v13, v106, v23
    v_fma_f32 v24, -v14, v106, v24
    v_fma_f32 v25, -v15, v106, v25
    v_fma_f32 v26, -v16, v106, v26
    v_fma_f32 v27, -v17, v106, v27
    v_fma_f32 v28, -v18, v106, v28
    v_fmac_f32 v10, v20, v107
    v_fmac_f32 v11, v21, v107
    v_fmac_f32 v12, v22, v107
    v_fmac_f32 v13, v23, v107
    v_fmac_f32 v14, v24, v107
    v_fmac_f32 v15, v25, v107
    v_fmac_f32 v16, v26, v107
    v_fmac_f32 v17, v27, v107
    v_fmac_f32 v18, v28, v107
    v_cvt_pk_bf16_f32 v4, v10, v11
    v_cvt_pk_bf16_f32 v5, v12, v13
    v_cvt_pk_bf16_f32 v6, v14, v15
    v_cvt_pk_bf16_f32 v7, v16, v17
    v_cvt_pk_bf16_f32 v8, v18, v18
    ds_write_b128 v3, v[4:7] offset:0
    ds_write_b16 v9, v8 offset:1024
    s_lshl_b32 s9, s8, 1
    v_lshl_add_u32 v2, v19, 1, s9
    s_waitcnt lgkmcnt(0)
    v_mov_b32 v30, 3088
    s_mov_b32 s12, 0
L_gn_24:
    ds_read_b64 v[114:115], v30
    s_add_u32 s12, s12, 1
    s_waitcnt lgkmcnt(0)
    v_cmp_ne_u32 vcc, 0, v114
    s_cmp_gt_u32 s12, 1600000
    s_cbranch_scc1 L_gnd_25
    s_cbranch_vccnz L_gnd_25
    s_sleep 1
    s_branch L_gn_24
L_gnd_25:
    v_readfirstlane_b32 s16, v114
    v_readfirstlane_b32 s17, v115
    s_nop 1
    ds_read_u16 v10, v2 offset:0
    ds_read_u16 v11, v2 offset:16
    ds_read_u16 v12, v2 offset:32
    ds_read_u16 v13, v2 offset:48
    ds_read_u16 v14, v2 offset:64
    ds_read_u16 v15, v2 offset:80
    ds_read_u16 v16, v2 offset:96
    ds_read_u16 v17, v2 offset:112
    ds_read_u16 v18, v2 offset:128
    ds_read_u16 v19, v2 offset:144
    ds_read_u16 v20, v2 offset:160
    ds_read_u16 v21, v2 offset:176
    s_waitcnt lgkmcnt(11)
    v_lshlrev_b32 v28, 16, v10
    s_waitcnt vmcnt(17)
    v_dot2_f32_bf16 v104, v32, v10, 0
    v_dot2_f32_bf16 v105, v32, v28, 0
    v_dot2_f32_bf16 v106, v33, v10, 0
    v_dot2_f32_bf16 v107, v33, v28, 0
    v_dot2_f32_bf16 v108, v34, v10, 0
    v_dot2_f32_bf16 v109, v34, v28, 0
    v_dot2_f32_bf16 v110, v35, v10, 0
    v_dot2_f32_bf16 v111, v35, v28, 0
    s_waitcnt lgkmcnt(10)
    v_lshlrev_b32 v29, 16, v11
    s_waitcnt vmcnt(16)
    v_dot2_f32_bf16 v104, v36, v11, v104
    v_dot2_f32_bf16 v105, v36, v29, v105
    v_dot2_f32_bf16 v106, v37, v11, v106
    v_dot2_f32_bf16 v107, v37, v29, v107
    v_dot2_f32_bf16 v108, v38, v11, v108
    v_dot2_f32_bf16 v109, v38, v29, v109
    v_dot2_f32_bf16 v110, v39, v11, v110
    v_dot2_f32_bf16 v111, v39, v29, v111
    s_waitcnt lgkmcnt(9)
    v_lshlrev_b32 v28, 16, v12
    s_waitcnt vmcnt(15)
    v_dot2_f32_bf16 v104, v40, v12, v104
    v_dot2_f32_bf16 v105, v40, v28, v105
    v_dot2_f32_bf16 v106, v41, v12, v106
    v_dot2_f32_bf16 v107, v41, v28, v107
    v_dot2_f32_bf16 v108, v42, v12, v108
    v_dot2_f32_bf16 v109, v42, v28, v109
    v_dot2_f32_bf16 v110, v43, v12, v110
    v_dot2_f32_bf16 v111, v43, v28, v111
    s_waitcnt lgkmcnt(8)
    v_lshlrev_b32 v29, 16, v13
    s_waitcnt vmcnt(14)
    v_dot2_f32_bf16 v104, v44, v13, v104
    v_dot2_f32_bf16 v105, v44, v29, v105
    v_dot2_f32_bf16 v106, v45, v13, v106
    v_dot2_f32_bf16 v107, v45, v29, v107
    v_dot2_f32_bf16 v108, v46, v13, v108
    v_dot2_f32_bf16 v109, v46, v29, v109
    v_dot2_f32_bf16 v110, v47, v13, v110
    v_dot2_f32_bf16 v111, v47, v29, v111
    s_waitcnt lgkmcnt(7)
    v_lshlrev_b32 v28, 16, v14
    s_waitcnt vmcnt(13)
    v_dot2_f32_bf16 v104, v48, v14, v104
    v_dot2_f32_bf16 v105, v48, v28, v105
    v_dot2_f32_bf16 v106, v49, v14, v106
    v_dot2_f32_bf16 v107, v49, v28, v107
    v_dot2_f32_bf16 v108, v50, v14, v108
    v_dot2_f32_bf16 v109, v50, v28, v109
    v_dot2_f32_bf16 v110, v51, v14, v110
    v_dot2_f32_bf16 v111, v51, v28, v111
    s_waitcnt lgkmcnt(6)
    v_lshlrev_b32 v29, 16, v15
    s_waitcnt vmcnt(12)
    v_dot2_f32_bf16 v104, v52, v15, v104
    v_dot2_f32_bf16 v105, v52, v29, v105
    v_dot2_f32_bf16 v106, v53, v15, v106
    v_dot2_f32_bf16 v107, v53, v29, v107
    v_dot2_f32_bf16 v108, v54, v15, v108
    v_dot2_f32_bf16 v109, v54, v29, v109
    v_dot2_f32_bf16 v110, v55, v15, v110
    v_dot2_f32_bf16 v111, v55, v29, v111
    s_waitcnt lgkmcnt(5)
    v_lshlrev_b32 v28, 16, v16
    s_waitcnt vmcnt(11)
    v_dot2_f32_bf16 v104, v56, v16, v104
    v_dot2_f32_bf16 v105, v56, v28, v105
    v_dot2_f32_bf16 v106, v57, v16, v106
    v_dot2_f32_bf16 v107, v57, v28, v107
    v_dot2_f32_bf16 v108, v58, v16, v108
    v_dot2_f32_bf16 v109, v58, v28, v109
    v_dot2_f32_bf16 v110, v59, v16, v110
    v_dot2_f32_bf16 v111, v59, v28, v111
    s_waitcnt lgkmcnt(4)
    v_lshlrev_b32 v29, 16, v17
    s_waitcnt vmcnt(10)
    v_dot2_f32_bf16 v104, v60, v17, v104
    v_dot2_f32_bf16 v105, v60, v29, v105
    v_dot2_f32_bf16 v106, v61, v17, v106
    v_dot2_f32_bf16 v107, v61, v29, v107
    v_dot2_f32_bf16 v108, v62, v17, v108
    v_dot2_f32_bf16 v109, v62, v29, v109
    v_dot2_f32_bf16 v110, v63, v17, v110
    v_dot2_f32_bf16 v111, v63, v29, v111
    s_waitcnt lgkmcnt(3)
    v_lshlrev_b32 v28, 16, v18
    s_waitcnt vmcnt(9)
    v_dot2_f32_bf16 v104, v64, v18, v104
    v_dot2_f32_bf16 v105, v64, v28, v105
    v_dot2_f32_bf16 v106, v65, v18, v106
    v_dot2_f32_bf16 v107, v65, v28, v107
    v_dot2_f32_bf16 v108, v66, v18, v108
    v_dot2_f32_bf16 v109, v66, v28, v109
    v_dot2_f32_bf16 v110, v67, v18, v110
    v_dot2_f32_bf16 v111, v67, v28, v111
    s_waitcnt lgkmcnt(2)
    v_lshlrev_b32 v29, 16, v19
    s_waitcnt vmcnt(8)
    v_dot2_f32_bf16 v104, v68, v19, v104
    v_dot2_f32_bf16 v105, v68, v29, v105
    v_dot2_f32_bf16 v106, v69, v19, v106
    v_dot2_f32_bf16 v107, v69, v29, v107
    v_dot2_f32_bf16 v108, v70, v19, v108
    v_dot2_f32_bf16 v109, v70, v29, v109
    v_dot2_f32_bf16 v110, v71, v19, v110
    v_dot2_f32_bf16 v111, v71, v29, v111
    s_waitcnt lgkmcnt(1)
    v_lshlrev_b32 v28, 16, v20
    s_waitcnt vmcnt(7)
    v_dot2_f32_bf16 v104, v72, v20, v104
    v_dot2_f32_bf16 v105, v72, v28, v105
    v_dot2_f32_bf16 v106, v73, v20, v106
    v_dot2_f32_bf16 v107, v73, v28, v107
    v_dot2_f32_bf16 v108, v74, v20, v108
    v_dot2_f32_bf16 v109, v74, v28, v109
    v_dot2_f32_bf16 v110, v75, v20, v110
    v_dot2_f32_bf16 v111, v75, v28, v111
    s_waitcnt lgkmcnt(0)
    v_lshlrev_b32 v29, 16, v21
    s_waitcnt vmcnt(6)
    v_dot2_f32_bf16 v104, v76, v21, v104
    v_dot2_f32_bf16 v105, v76, v29, v105
    v_dot2_f32_bf16 v106, v77, v21, v106
    v_dot2_f32_bf16 v107, v77, v29, v107
    v_dot2_f32_bf16 v108, v78, v21, v108
    v_dot2_f32_bf16 v109, v78, v29, v109
    v_dot2_f32_bf16 v110, v79, v21, v110
    v_dot2_f32_bf16 v111, v79, v29, v111
    s_nop 2
    ds_read_u16 v10, v2 offset:192
    ds_read_u16 v11, v2 offset:208
    ds_read_u16 v12, v2 offset:224
    ds_read_u16 v13, v2 offset:240
    ds_read_u16 v14, v2 offset:256
    ds_read_u16 v15, v2 offset:272
    s_waitcnt lgkmcnt(5)
    v_lshlrev_b32 v28, 16, v10
    s_waitcnt vmcnt(5)
    v_dot2_f32_bf16 v104, v80, v10, v104
    v_dot2_f32_bf16 v105, v80, v28, v105
    v_dot2_f32_bf16 v106, v81, v10, v106
    v_dot2_f32_bf16 v107, v81, v28, v107
    v_dot2_f32_bf16 v108, v82, v10, v108
    v_dot2_f32_bf16 v109, v82, v28, v109
    v_dot2_f32_bf16 v110, v83, v10, v110
    v_dot2_f32_bf16 v111, v83, v28, v111
    s_waitcnt lgkmcnt(4)
    v_lshlrev_b32 v29, 16, v11
    s_waitcnt vmcnt(4)
    v_dot2_f32_bf16 v104, v84, v11, v104
    v_dot2_f32_bf16 v105, v84, v29, v105
    v_dot2_f32_bf16 v106, v85, v11, v106
    v_dot2_f32_bf16 v107, v85, v29, v107
    v_dot2_f32_bf16 v108, v86, v11, v108
    v_dot2_f32_bf16 v109, v86, v29, v109
    v_dot2_f32_bf16 v110, v87, v11, v110
    v_dot2_f32_bf16 v111, v87, v29, v111
    s_waitcnt lgkmcnt(3)
    v_lshlrev_b32 v28, 16, v12
    s_waitcnt vmcnt(3)
    v_dot2_f32_bf16 v104, v88, v12, v104
    v_dot2_f32_bf16 v105, v88, v28, v105
    v_dot2_f32_bf16 v106, v89, v12, v106
    v_dot2_f32_bf16 v107, v89, v28, v107
    v_dot2_f32_bf16 v108, v90, v12, v108
    v_dot2_f32_bf16 v109, v90, v28, v109
    v_dot2_f32_bf16 v110, v91, v12, v110
    v_dot2_f32_bf16 v111, v91, v28, v111
    s_waitcnt lgkmcnt(2)
    v_lshlrev_b32 v29, 16, v13
    s_waitcnt vmcnt(2)
    v_dot2_f32_bf16 v104, v92, v13, v104
    v_dot2_f32_bf16 v105, v92, v29, v105
    v_dot2_f32_bf16 v106, v93, v13, v106
    v_dot2_f32_bf16 v107, v93, v29, v107
    v_dot2_f32_bf16 v108, v94, v13, v108
    v_dot2_f32_bf16 v109, v94, v29, v109
    v_dot2_f32_bf16 v110, v95, v13, v110
    v_dot2_f32_bf16 v111, v95, v29, v111
    s_waitcnt lgkmcnt(1)
    v_lshlrev_b32 v28, 16, v14
    s_waitcnt vmcnt(1)
    v_dot2_f32_bf16 v104, v96, v14, v104
    v_dot2_f32_bf16 v105, v96, v28, v105
    v_dot2_f32_bf16 v106, v97, v14, v106
    v_dot2_f32_bf16 v107, v97, v28, v107
    v_dot2_f32_bf16 v108, v98, v14, v108
    v_dot2_f32_bf16 v109, v98, v28, v109
    v_dot2_f32_bf16 v110, v99, v14, v110
    v_dot2_f32_bf16 v111, v99, v28, v111
    s_waitcnt lgkmcnt(0)
    v_lshlrev_b32 v29, 16, v15
    s_waitcnt vmcnt(0)
    v_dot2_f32_bf16 v104, v100, v15, v104
    v_dot2_f32_bf16 v105, v100, v29, v105
    v_dot2_f32_bf16 v106, v101, v15, v106
    v_dot2_f32_bf16 v107, v101, v29, v107
    v_dot2_f32_bf16 v108, v102, v15, v108
    v_dot2_f32_bf16 v109, v102, v29, v109
    v_dot2_f32_bf16 v110, v103, v15, v110
    v_dot2_f32_bf16 v111, v103, v29, v111
    s_nop 2
    s_nop 2
    v_permlane32_swap_b32 v104, v108
    v_permlane32_swap_b32 v105, v109
    v_permlane32_swap_b32 v106, v110
    v_permlane32_swap_b32 v107, v111
    s_nop 0
    v_add_f32 v104, v104, v108
    v_add_f32 v105, v105, v109
    v_add_f32 v106, v106, v110
    v_add_f32 v107, v107, v111
    s_nop 1
    v_permlane16_swap_b32 v104, v106
    v_permlane16_swap_b32 v105, v107
    s_nop 0
    v_add_f32 v104, v104, v106
    v_add_f32 v105, v105, v107
    s_nop 1
    v_add_f32_dpp v104, v104, v104 row_ror:8 row_mask:0xf bank_mask:0xf
    v_add_f32_dpp v105, v105, v105 row_ror:8 row_mask:0xf bank_mask:0xf
    v_mov_b32 v12, s16
    v_mov_b32 v13, v104
    v_mov_b32 v14, v105
    v_mov_b32 v15, s17
    v_and_b32 v2, 7, v1
    v_lshlrev_b32 v2, 6, v2
    v_lshrrev_b32 v10, 5, v1
    v_lshl_add_u32 v2, v10, 5, v2
    v_bfe_u32 v10, v1, 4, 1
    v_lshl_add_u32 v2, v10, 4, v2
    s_lshl_b32 s9, s2, 13
    v_and_b32 v10, 8, v1
    v_cmp_eq_u32 vcc, 0, v10
    s_and_saveexec_b64 s[20:21], vcc
    buffer_store_dwordx4 v[12:15], v2, s[88:91], s9 offen sc1
    s_lshl_b32 s9, s4, 17
    s_lshl_b32 s10, s5, 4
    v_mov_b32 v2, s10
    v_cmp_eq_u32 vcc, 0, v1
    s_and_b64 exec, exec, vcc
    buffer_store_dwordx4 v[12:15], v2, s[88:91], s9 offen offset:3840 sc1
    s_mov_b64 exec, s[20:21]
    v_and_b32 v2, 15, v1
    v_lshlrev_b32 v2, 4, v2
    s_mov_b32 s12, 0
L_poll_26:
    buffer_load_dwordx4 v[32:35], v2, s[88:91], s9 offen offset:3840 sc1
    s_add_u32 s12, s12, 1
    s_waitcnt vmcnt(0)
    v_xor_b32 v21, s16, v32
    v_xor_b32 v22, s17, v35
    v_or_b32 v20, v21, v22
    v_cmp_ne_u32 vcc, 0, v20
    s_cmp_gt_u32 s12, 400000
    s_cbranch_scc1 L_polld_27
    s_cbranch_vccz L_polld_27
    s_sleep 2
    s_branch L_poll_26
L_polld_27:
    s_lshl_b32 s9, s4, 17
    v_and_b32 v3, 31, v1
    v_lshlrev_b32 v3, 4, v3
    v_lshrrev_b32 v10, 5, v1
    v_lshl_add_u32 v3, v10, 15, v3
    s_mov_b32 s12, 0
L_poll_28:
    s_add_u32 s10, s9, 0
    buffer_load_dwordx4 v[32:35], v3, s[88:91], s10 offen sc1
    s_add_u32 s10, s9, 8192
    buffer_load_dwordx4 v[36:39], v3, s[88:91], s10 offen sc1
    s_add_u32 s10, s9, 16384
    buffer_load_dwordx4 v[40:43], v3, s[88:91], s10 offen sc1
    s_add_u32 s10, s9, 24576
    buffer_load_dwordx4 v[44:47], v3, s[88:91], s10 offen sc1
    s_add_u32 s10, s9, 65536
    buffer_load_dwordx4 v[48:51], v3, s[88:91], s10 offen sc1
    s_add_u32 s10, s9, 73728
    buffer_load_dwordx4 v[52:55], v3, s[88:91], s10 offen sc1
    s_add_u32 s10, s9, 81920
    buffer_load_dwordx4 v[56:59], v3, s[88:91], s10 offen sc1
    s_add_u32 s10, s9, 90112
    buffer_load_dwordx4 v[60:63], v3, s[88:91], s10 offen sc1
    s_add_u32 s12, s12, 1
    s_waitcnt vmcnt(0)
    v_xor_b32 v21, s16, v32
    v_xor_b32 v22, s17, v35
    v_or_b32 v20, v21, v22
    v_xor_b32 v21, s16, v36
    v_xor_b32 v22, s17, v39
    v_or3_b32 v20, v20, v21, v22
    v_xor_b32 v21, s16, v40
    v_xor_b32 v22, s17, v43
    v_or3_b32 v20, v20, v21, v22
    v_xor_b32 v21, s16, v44
    v_xor_b32 v22, s17, v47
    v_or3_b32 v20, v20, v21, v22
    v_xor_b32 v21, s16, v48
    v_xor_b32 v22, s17, v51
    v_or3_b32 v20, v20, v21, v22
    v_xor_b32 v21, s16, v52
    v_xor_b32 v22, s17, v55
    v_or3_b32 v20, v20, v21, v22
    v_xor_b32 v21, s16, v56
    v_xor_b32 v22, s17, v59
    v_or3_b32 v20, v20, v21, v22
    v_xor_b32 v21, s16, v60
    v_xor_b32 v22, s17, v63
    v_or3_b32 v20, v20, v21, v22
    v_cmp_ne_u32 vcc, 0, v20
    s_cmp_gt_u32 s12, 400000
    s_cbranch_scc1 L_polld_29
    s_cbranch_vccz L_polld_29
    s_branch L_poll_28
L_polld_29:
    v_add_f32 v33, v33, v37
    v_add_f32 v41, v41, v45
    v_add_f32 v34, v34, v38
    v_add_f32 v42, v42, v46
    v_add_f32 v49, v49, v53
    v_add_f32 v57, v57, v61
    v_add_f32 v50, v50, v54
    v_add_f32 v58, v58, v62
    v_add_f32 v33, v33, v41
    v_add_f32 v34, v34, v42
    v_add_f32 v49, v49, v57
    v_add_f32 v50, v50, v58
    v_cvt_pk_bf16_f32 v32, v33, v34
    v_cvt_pk_bf16_f32 v33, v49, v50
    v_lshlrev_b32 v4, 2, v1
    ds_write_b32 v4, v32 offset:2432
    ds_write_b32 v4, v33 offset:2688
    s_waitcnt lgkmcnt(0)
    v_mov_b32 v10, 3076
    v_mov_b32 v11, 1
    ds_write_b32 v10, v11
    s_waitcnt lgkmcnt(0)
    v_lshrrev_b32 v4, 4, v1
    v_lshlrev_b32 v4, 14, v4
    v_and_b32 v5, 15, v1
    v_lshl_add_u32 v5, v5, 4, v4
    s_lshl_b32 s9, s4, 16
    s_add_u32 s9, s9, 2097152
    s_lshr_b32 s11, s5, 2
    s_lshl_b32 s10, s11, 8
    s_add_u32 s10, s10, s9
    s_lshr_b32 s11, s5, 3
    s_lshl_b32 s11, s11, 4
    s_add_u32 s11, s11, s9
    v_mov_b32 v10, 3084
    s_mov_b32 s12, 0
L_spin_30:
    ds_read_b32 v11, v10
    s_add_u32 s12, s12, 1
    s_waitcnt lgkmcnt(0)
    v_cmp_ne_u32 vcc, 0, v11
    s_cmp_gt_u32 s12, 1600000
    s_cbranch_scc1 L_spind_31
    s_cbranch_vccnz L_spind_31
    s_sleep 2
    s_branch L_spin_30
L_spind_31:
    s_mov_b32 s12, 0
L_poll_32:
    s_add_u32 s13, s10, 0
    s_add_u32 s15, s11, 0
    buffer_load_dwordx4 v[32:35], v5, s[88:91], s13 offen sc1
    buffer_load_dwordx4 v[36:39], v5, s[88:91], s13 offen offset:1024 sc1
    buffer_load_dwordx4 v[40:43], v4, s[88:91], s15 offen offset:2048 sc1
    s_add_u32 s13, s10, 4096
    s_add_u32 s15, s11, 4096
    buffer_load_dwordx4 v[44:47], v5, s[88:91], s13 offen sc1
    buffer_load_dwordx4 v[48:51], v5, s[88:91], s13 offen offset:1024 sc1
    buffer_load_dwordx4 v[52:55], v4, s[88:91], s15 offen offset:2048 sc1
    s_add_u32 s13, s10, 8192
    s_add_u32 s15, s11, 8192
    buffer_load_dwordx4 v[56:59], v5, s[88:91], s13 offen sc1
    buffer_load_dwordx4 v[60:63], v5, s[88:91], s13 offen offset:1024 sc1
    buffer_load_dwordx4 v[64:67], v4, s[88:91], s15 offen offset:2048 sc1
    s_add_u32 s13, s10, 12288
    s_add_u32 s15, s11, 12288
    buffer_load_dwordx4 v[68:71], v5, s[88:91], s13 offen sc1
    buffer_load_dwordx4 v[72:75], v5, s[88:91], s13 offen offset:1024 sc1
    buffer_load_dwordx4 v[76:79], v4, s[88:91], s15 offen offset:2048 sc1
    s_add_u32 s12, s12, 1
    s_waitcnt vmcnt(0)
    v_xor_b32 v21, s16, v32
    v_xor_b32 v22, s17, v35
    v_or_b32 v20, v21, v22
    v_xor_b32 v21, s16, v36
    v_xor_b32 v22, s17, v39
    v_or3_b32 v20, v20, v21, v22
    v_xor_b32 v21, s16, v40
    v_xor_b32 v22, s17, v43
    v_or3_b32 v20, v20, v21, v22
    v_xor_b32 v21, s16, v44
    v_xor_b32 v22, s17, v47
    v_or3_b32 v20, v20, v21, v22
    v_xor_b32 v21, s16, v48
    v_xor_b32 v22, s17, v51
    v_or3_b32 v20, v20, v21, v22
    v_xor_b32 v21, s16, v52
    v_xor_b32 v22, s17, v55
    v_or3_b32 v20, v20, v21, v22
    v_xor_b32 v21, s16, v56
    v_xor_b32 v22, s17, v59
    v_or3_b32 v20, v20, v21, v22
    v_xor_b32 v21, s16, v60
    v_xor_b32 v22, s17, v63
    v_or3_b32 v20, v20, v21, v22
    v_xor_b32 v21, s16, v64
    v_xor_b32 v22, s17, v67
    v_or3_b32 v20, v20, v21, v22
    v_xor_b32 v21, s16, v68
    v_xor_b32 v22, s17, v71
    v_or3_b32 v20, v20, v21, v22
    v_xor_b32 v21, s16, v72
    v_xor_b32 v22, s17, v75
    v_or3_b32 v20, v20, v21, v22
    v_xor_b32 v21, s16, v76
    v_xor_b32 v22, s17, v79
    v_or3_b32 v20, v20, v21, v22
    v_cmp_ne_u32 vcc, 0, v20
    s_cmp_gt_u32 s12, 400000
    s_cbranch_scc1 L_polld_33
    s_cbranch_vccz L_polld_33
    s_sleep 2
    s_branch L_poll_32
L_polld_33:
    v_max3_f32 v84, v41, v53, v65
    v_max_f32 v84, v84, v77
    v_mov_b32 v85, v84
    s_nop 1
    v_permlane16_swap_b32 v84, v85
    s_nop 0
    v_max_f32 v84, v84, v85
    v_mov_b32 v85, v84
    s_nop 1
    v_permlane32_swap_b32 v84, v85
    s_nop 0
    v_max_f32 v84, v84, v85
    v_sub_f32 v41, v41, v84
    v_sub_f32 v53, v53, v84
    v_sub_f32 v65, v65, v84
    v_sub_f32 v77, v77, v84
    v_mul_f32 v41, s24, v41
    v_mul_f32 v53, s24, v53
    v_mul_f32 v65, s24, v65
    v_mul_f32 v77, s24, v77
    v_exp_f32 v41, v41
    v_exp_f32 v53, v53
    v_exp_f32 v65, v65
    v_exp_f32 v77, v77
    s_nop 0
    v_mul_f32 v86, v41, v33
    v_mul_f32 v87, v41, v34
    v_mul_f32 v88, v41, v37
    v_mul_f32 v89, v41, v38
    v_mul_f32 v90, v41, v42
    v_fmac_f32 v86, v53, v45
    v_fmac_f32 v87, v53, v46
    v_fmac_f32 v88, v53, v49
    v_fmac_f32 v89, v53, v50
    v_fmac_f32 v90, v53, v54
    v_fmac_f32 v86, v65, v57
    v_fmac_f32 v87, v65, v58
    v_fmac_f32 v88, v65, v61
    v_fmac_f32 v89, v65, v62
    v_fmac_f32 v90, v65, v66
    v_fmac_f32 v86, v77, v69
    v_fmac_f32 v87, v77, v70
    v_fmac_f32 v88, v77, v73
    v_fmac_f32 v89, v77, v74
    v_fmac_f32 v90, v77, v78
    v_mov_b32 v91, v86
    v_mov_b32 v92, v87
    v_mov_b32 v93, v88
    v_mov_b32 v94, v89
    v_mov_b32 v95, v90
    s_nop 1
    v_permlane16_swap_b32 v86, v91
    v_permlane16_swap_b32 v87, v92
    v_permlane16_swap_b32 v88, v93
    v_permlane16_swap_b32 v89, v94
    v_permlane16_swap_b32 v90, v95
    s_nop 0
    v_add_f32 v86, v86, v91
    v_add_f32 v87, v87, v92
    v_add_f32 v88, v88, v93
    v_add_f32 v89, v89, v94
    v_add_f32 v90, v90, v95
    v_mov_b32 v91, v86
    v_mov_b32 v92, v87
    v_mov_b32 v93, v88
    v_mov_b32 v94, v89
    v_mov_b32 v95, v90
    s_nop 1
    v_permlane32_swap_b32 v86, v91
    v_permlane32_swap_b32 v87, v92
    v_permlane32_swap_b32 v88, v93
    v_permlane32_swap_b32 v89, v94
    v_permlane32_swap_b32 v90, v95
    s_nop 0
    v_add_f32 v86, v86, v91
    v_add_f32 v87, v87, v92
    v_add_f32 v88, v88, v93
    v_add_f32 v89, v89, v94
    v_add_f32 v90, v90, v95
    v_rcp_f32 v90, v90
    s_nop 0
    v_mul_f32 v86, v90, v86
    v_mul_f32 v87, v90, v87
    v_mul_f32 v88, v90, v88
    v_mul_f32 v89, v90, v89
    v_cvt_pk_bf16_f32 v86, v86, v87
    v_cvt_pk_bf16_f32 v87, v88, v89
    v_cmp_gt_u32 vcc, 16, v1
    s_nop 1
    v_cndmask_b32 v86, 0, v86, vcc
    v_cndmask_b32 v87, 0, v87, vcc
    v_lshlrev_b32 v4, 3, v1
    v_cmp_gt_u32 vcc, 24, v1
    s_and_saveexec_b64 s[20:21], vcc
    ds_write_b64 v4, v[86:87] offset:5184
    s_mov_b64 exec, s[20:21]
    s_waitcnt lgkmcnt(0)
    s_barrier
    s_endpgm
L_w1b:
    s_barrier
    s_waitcnt vmcnt(24)
    v_lshlrev_b32 v10, 16, v4
    v_and_b32 v11, s25, v4
    v_lshlrev_b32 v12, 16, v5
    v_and_b32 v13, s25, v5
    v_lshlrev_b32 v14, 16, v6
    v_and_b32 v15, s25, v6
    v_lshlrev_b32 v16, 16, v7
    v_and_b32 v17, s25, v7
    v_lshlrev_b32 v18, 16, v8
    v_add_f32 v144, v10, v11
    v_add_f32 v145, v12, v13
    v_add_f32 v146, v14, v15
    v_add_f32 v147, v16, v17
    v_add_f32 v144, v144, v145
    v_add_f32 v146, v146, v147
    v_add_f32 v144, v144, v18
    v_add_f32 v144, v144, v146
    s_nop 1
    v_add_f32_dpp v144, v144, v144 row_ror:8 row_mask:0xf bank_mask:0xf
    s_nop 1
    v_add_f32_dpp v144, v144, v144 row_ror:4 row_mask:0xf bank_mask:0xf
    s_nop 1
    v_add_f32_dpp v144, v144, v144 row_ror:2 row_mask:0xf bank_mask:0xf
    s_nop 1
    v_add_f32_dpp v144, v144, v144 row_ror:1 row_mask:0xf bank_mask:0xf
    v_mov_b32 v145, v144
    s_nop 1
    v_permlane16_swap_b32 v144, v145
    s_nop 0
    v_add_f32 v144, v144, v145
    v_mov_b32 v145, v144
    s_nop 1
    v_permlane32_swap_b32 v144, v145
    s_nop 0
    v_add_f32 v144, v144, v145
    v_mul_f32 v144, 0x3ae38e39, v144
    v_sub_f32 v20, v10, v144
    v_sub_f32 v21, v11, v144
    v_sub_f32 v22, v12, v144
    v_sub_f32 v23, v13, v144
    v_sub_f32 v24, v14, v144
    v_sub_f32 v25, v15, v144
    v_sub_f32 v26, v16, v144
    v_sub_f32 v27, v17, v144
    v_sub_f32 v28, v18, v144
    v_mul_f32 v146, v20, v20
    v_mul_f32 v147, v21, v21
    v_mul_f32 v148, v22, v22
    v_fmac_f32 v146, v23, v23
    v_fmac_f32 v147, v24, v24
    v_fmac_f32 v148, v25, v25
    v_fmac_f32 v146, v26, v26
    v_fmac_f32 v147, v27, v27
    v_fmac_f32 v148, v28, v28
    v_add_f32 v146, v146, v147
    v_add_f32 v146, v146, v148
    s_nop 1
    v_add_f32_dpp v146, v146, v146 row_ror:8 row_mask:0xf bank_mask:0xf
    s_nop 1
    v_add_f32_dpp v146, v146, v146 row_ror:4 row_mask:0xf bank_mask:0xf
    s_nop 1
    v_add_f32_dpp v146, v146, v146 row_ror:2 row_mask:0xf bank_mask:0xf
    s_nop 1
    v_add_f32_dpp v146, v146, v146 row_ror:1 row_mask:0xf bank_mask:0xf
    v_mov_b32 v145, v146
    s_nop 1
    v_permlane16_swap_b32 v146, v145
    s_nop 0
    v_add_f32 v146, v146, v145
    v_mov_b32 v145, v146
    s_nop 1
    v_permlane32_swap_b32 v146, v145
    s_nop 0
    v_add_f32 v146, v146, v145
    v_mul_f32 v146, 0x3ae38e39, v146
    v_cvt_pk_bf16_f32 v145, v144, v146
    v_lshlrev_b32 v144, 16, v145
    v_and_b32 v146, s25, v145
    v_add_f32 v146, 0x3727c5ac, v146
    v_cvt_pk_bf16_f32 v146, v146, v146
    v_and_b32 v146, s25, v146
    v_sqrt_f32 v146, v146
    s_nop 0
    v_cvt_pk_bf16_f32 v146, v146, v146
    v_and_b32 v146, s25, v146
    v_rcp_f32 v147, v146
    v_sub_f32 v20, v10, v144
    v_sub_f32 v21, v11, v144
    v_sub_f32 v22, v12, v144
    v_sub_f32 v23, v13, v144
    v_sub_f32 v24, v14, v144
    v_sub_f32 v25, v15, v144
    v_sub_f32 v26, v16, v144
    v_sub_f32 v27, v17, v144
    v_sub_f32 v28, v18, v144
    v_cvt_pk_bf16_f32 v148, v20, v21
    v_cvt_pk_bf16_f32 v149, v22, v23
    v_cvt_pk_bf16_f32 v150, v24, v25
    v_cvt_pk_bf16_f32 v151, v26, v27
    v_cvt_pk_bf16_f32 v152, v28, v28
    v_lshlrev_b32 v20, 16, v148
    v_and_b32 v21, s25, v148
    v_lshlrev_b32 v22, 16, v149
    v_and_b32 v23, s25, v149
    v_lshlrev_b32 v24, 16, v150
    v_and_b32 v25, s25, v150
    v_lshlrev_b32 v26, 16, v151
    v_and_b32 v27, s25, v151
    v_lshlrev_b32 v28, 16, v152
    v_mul_f32 v10, v20, v147
    v_mul_f32 v11, v21, v147
    v_mul_f32 v12, v22, v147
    v_mul_f32 v13, v23, v147
    v_mul_f32 v14, v24, v147
    v_mul_f32 v15, v25, v147
    v_mul_f32 v16, v26, v147
    v_mul_f32 v17, v27, v147
    v_mul_f32 v18, v28, v147
    v_fma_f32 v20, -v10, v146, v20
    v_fma_f32 v21, -v11, v146, v21
    v_fma_f32 v22, -v12, v146, v22
    v_fma_f32 v23, -v13, v146, v23
    v_fma_f32 v24, -v14, v146, v24
    v_fma_f32 v25, -v15, v146, v25
    v_fma_f32 v26, -v16, v146, v26
    v_fma_f32 v27, -v17, v146, v27
    v_fma_f32 v28, -v18, v146, v28
    v_fmac_f32 v10, v20, v147
    v_fmac_f32 v11, v21, v147
    v_fmac_f32 v12, v22, v147
    v_fmac_f32 v13, v23, v147
    v_fmac_f32 v14, v24, v147
    v_fmac_f32 v15, v25, v147
    v_fmac_f32 v16, v26, v147
    v_fmac_f32 v17, v27, v147
    v_fmac_f32 v18, v28, v147
    v_cvt_pk_bf16_f32 v4, v10, v11
    v_cvt_pk_bf16_f32 v5, v12, v13
    v_cvt_pk_bf16_f32 v6, v14, v15
    v_cvt_pk_bf16_f32 v7, v16, v17
    v_cvt_pk_bf16_f32 v8, v18, v18
    v_lshlrev_b32 v10, 16, v4
    v_and_b32 v11, s25, v4
    v_lshlrev_b32 v12, 16, v5
    v_and_b32 v13, s25, v5
    v_lshlrev_b32 v14, 16, v6
    v_and_b32 v15, s25, v6
    v_lshlrev_b32 v16, 16, v7
    v_and_b32 v17, s25, v7
    v_lshlrev_b32 v18, 16, v8
    v_add_f32 v144, v10, v11
    v_add_f32 v145, v12, v13
    v_add_f32 v146, v14, v15
    v_add_f32 v147, v16, v17
    v_add_f32 v144, v144, v145
    v_add_f32 v146, v146, v147
    v_add_f32 v144, v144, v18
    v_add_f32 v144, v144, v146
    s_nop 1
    v_add_f32_dpp v144, v144, v144 row_ror:8 row_mask:0xf bank_mask:0xf
    s_nop 1
    v_add_f32_dpp v144, v144, v144 row_ror:4 row_mask:0xf bank_mask:0xf
    s_nop 1
    v_add_f32_dpp v144, v144, v144 row_ror:2 row_mask:0xf bank_mask:0xf
    s_nop 1
    v_add_f32_dpp v144, v144, v144 row_ror:1 row_mask:0xf bank_mask:0xf
    v_mov_b32 v145, v144
    s_nop 1
    v_permlane16_swap_b32 v144, v145
    s_nop 0
    v_add_f32 v144, v144, v145
    v_mov_b32 v145, v144
    s_nop 1
    v_permlane32_swap_b32 v144, v145
    s_nop 0
    v_add_f32 v144, v144, v145
    v_mul_f32 v144, 0x3ae38e39, v144
    v_sub_f32 v20, v10, v144
    v_sub_f32 v21, v11, v144
    v_sub_f32 v22, v12, v144
    v_sub_f32 v23, v13, v144
    v_sub_f32 v24, v14, v144
    v_sub_f32 v25, v15, v144
    v_sub_f32 v26, v16, v144
    v_sub_f32 v27, v17, v144
    v_sub_f32 v28, v18, v144
    v_mul_f32 v146, v20, v20
    v_mul_f32 v147, v21, v21
    v_mul_f32 v148, v22, v22
    v_fmac_f32 v146, v23, v23
    v_fmac_f32 v147, v24, v24
    v_fmac_f32 v148, v25, v25
    v_fmac_f32 v146, v26, v26
    v_fmac_f32 v147, v27, v27
    v_fmac_f32 v148, v28, v28
    v_add_f32 v146, v146, v147
    v_add_f32 v146, v146, v148
    s_nop 1
    v_add_f32_dpp v146, v146, v146 row_ror:8 row_mask:0xf bank_mask:0xf
    s_nop 1
    v_add_f32_dpp v146, v146, v146 row_ror:4 row_mask:0xf bank_mask:0xf
    s_nop 1
    v_add_f32_dpp v146, v146, v146 row_ror:2 row_mask:0xf bank_mask:0xf
    s_nop 1
    v_add_f32_dpp v146, v146, v146 row_ror:1 row_mask:0xf bank_mask:0xf
    v_mov_b32 v145, v146
    s_nop 1
    v_permlane16_swap_b32 v146, v145
    s_nop 0
    v_add_f32 v146, v146, v145
    v_mov_b32 v145, v146
    s_nop 1
    v_permlane32_swap_b32 v146, v145
    s_nop 0
    v_add_f32 v146, v146, v145
    v_mul_f32 v146, 0x3ae38e39, v146
    v_cvt_pk_bf16_f32 v145, v144, v146
    v_lshlrev_b32 v144, 16, v145
    v_and_b32 v146, s25, v145
    v_add_f32 v146, 0x3727c5ac, v146
    v_cvt_pk_bf16_f32 v146, v146, v146
    v_and_b32 v146, s25, v146
    v_sqrt_f32 v146, v146
    s_nop 0
    v_cvt_pk_bf16_f32 v146, v146, v146
    v_and_b32 v146, s25, v146
    v_rcp_f32 v147, v146
    v_sub_f32 v20, v10, v144
    v_sub_f32 v21, v11, v144
    v_sub_f32 v22, v12, v144
    v_sub_f32 v23, v13, v144
    v_sub_f32 v24, v14, v144
    v_sub_f32 v25, v15, v144
    v_sub_f32 v26, v16, v144
    v_sub_f32 v27, v17, v144
    v_sub_f32 v28, v18, v144
    v_cvt_pk_bf16_f32 v148, v20, v21
    v_cvt_pk_bf16_f32 v149, v22, v23
    v_cvt_pk_bf16_f32 v150, v24, v25
    v_cvt_pk_bf16_f32 v151, v26, v27
    v_cvt_pk_bf16_f32 v152, v28, v28
    v_lshlrev_b32 v20, 16, v148
    v_and_b32 v21, s25, v148
    v_lshlrev_b32 v22, 16, v149
    v_and_b32 v23, s25, v149
    v_lshlrev_b32 v24, 16, v150
    v_and_b32 v25, s25, v150
    v_lshlrev_b32 v26, 16, v151
    v_and_b32 v27, s25, v151
    v_lshlrev_b32 v28, 16, v152
    v_mul_f32 v10, v20, v147
    v_mul_f32 v11, v21, v147
    v_mul_f32 v12, v22, v147
    v_mul_f32 v13, v23, v147
    v_mul_f32 v14, v24, v147
    v_mul_f32 v15, v25, v147
    v_mul_f32 v16, v26, v147
    v_mul_f32 v17, v27, v147
    v_mul_f32 v18, v28, v147
    v_fma_f32 v20, -v10, v146, v20
    v_fma_f32 v21, -v11, v146, v21
    v_fma_f32 v22, -v12, v146, v22
    v_fma_f32 v23, -v13, v146, v23
    v_fma_f32 v24, -v14, v146, v24
    v_fma_f32 v25, -v15, v146, v25
    v_fma_f32 v26, -v16, v146, v26
    v_fma_f32 v27, -v17, v146, v27
    v_fma_f32 v28, -v18, v146, v28
    v_fmac_f32 v10, v20, v147
    v_fmac_f32 v11, v21, v147
    v_fmac_f32 v12, v22, v147
    v_fmac_f32 v13, v23, v147
    v_fmac_f32 v14, v24, v147
    v_fmac_f32 v15, v25, v147
    v_fmac_f32 v16, v26, v147
    v_fmac_f32 v17, v27, v147
    v_fmac_f32 v18, v28, v147
    v_cvt_pk_bf16_f32 v4, v10, v11
    v_cvt_pk_bf16_f32 v5, v12, v13
    v_cvt_pk_bf16_f32 v6, v14, v15
    v_cvt_pk_bf16_f32 v7, v16, v17
    v_cvt_pk_bf16_f32 v8, v18, v18
    ds_write_b128 v3, v[4:7] offset:1216
    ds_write_b16 v9, v8 offset:2240
    s_lshl_b32 s9, s8, 1
    v_min_u32 v2, 2, v140
    v_lshl_add_u32 v2, v2, 1, s9
    s_waitcnt lgkmcnt(0)
    v_mov_b32 v30, 3088
    s_mov_b32 s12, 0
L_gn_34:
    ds_read_b64 v[144:145], v30
    s_add_u32 s12, s12, 1
    s_waitcnt lgkmcnt(0)
    v_cmp_ne_u32 vcc, 0, v144
    s_cmp_gt_u32 s12, 1600000
    s_cbranch_scc1 L_gnd_35
    s_cbranch_vccnz L_gnd_35
    s_sleep 1
    s_branch L_gn_34
L_gnd_35:
    v_readfirstlane_b32 s16, v144
    v_readfirstlane_b32 s17, v145
    s_nop 1
    ds_read_u16 v10, v2 offset:1216
    ds_read_u16 v11, v2 offset:1222
    ds_read_u16 v12, v2 offset:1228
    ds_read_u16 v13, v2 offset:1234
    ds_read_u16 v14, v2 offset:1240
    ds_read_u16 v15, v2 offset:1246
    ds_read_u16 v16, v2 offset:1252
    ds_read_u16 v17, v2 offset:1258
    ds_read_u16 v18, v2 offset:1264
    ds_read_u16 v19, v2 offset:1270
    ds_read_u16 v20, v2 offset:1276
    ds_read_u16 v21, v2 offset:1282
    s_waitcnt lgkmcnt(11)
    v_lshlrev_b32 v28, 16, v10
    s_waitcnt vmcnt(23)
    v_dot2_f32_bf16 v128, v32, v10, 0
    v_dot2_f32_bf16 v129, v32, v28, 0
    v_dot2_f32_bf16 v130, v33, v10, 0
    v_dot2_f32_bf16 v131, v33, v28, 0
    v_dot2_f32_bf16 v132, v34, v10, 0
    v_dot2_f32_bf16 v133, v34, v28, 0
    v_dot2_f32_bf16 v134, v35, v10, 0
    v_dot2_f32_bf16 v135, v35, v28, 0
    s_waitcnt lgkmcnt(10)
    v_lshlrev_b32 v29, 16, v11
    s_waitcnt vmcnt(22)
    v_dot2_f32_bf16 v128, v36, v11, v128
    v_dot2_f32_bf16 v129, v36, v29, v129
    v_dot2_f32_bf16 v130, v37, v11, v130
    v_dot2_f32_bf16 v131, v37, v29, v131
    v_dot2_f32_bf16 v132, v38, v11, v132
    v_dot2_f32_bf16 v133, v38, v29, v133
    v_dot2_f32_bf16 v134, v39, v11, v134
    v_dot2_f32_bf16 v135, v39, v29, v135
    s_waitcnt lgkmcnt(9)
    v_lshlrev_b32 v28, 16, v12
    s_waitcnt vmcnt(21)
    v_dot2_f32_bf16 v128, v40, v12, v128
    v_dot2_f32_bf16 v129, v40, v28, v129
    v_dot2_f32_bf16 v130, v41, v12, v130
    v_dot2_f32_bf16 v131, v41, v28, v131
    v_dot2_f32_bf16 v132, v42, v12, v132
    v_dot2_f32_bf16 v133, v42, v28, v133
    v_dot2_f32_bf16 v134, v43, v12, v134
    v_dot2_f32_bf16 v135, v43, v28, v135
    s_waitcnt lgkmcnt(8)
    v_lshlrev_b32 v29, 16, v13
    s_waitcnt vmcnt(20)
    v_dot2_f32_bf16 v128, v44, v13, v128
    v_dot2_f32_bf16 v129, v44, v29, v129
    v_dot2_f32_bf16 v130, v45, v13, v130
    v_dot2_f32_bf16 v131, v45, v29, v131
    v_dot2_f32_bf16 v132, v46, v13, v132
    v_dot2_f32_bf16 v133, v46, v29, v133
    v_dot2_f32_bf16 v134, v47, v13, v134
    v_dot2_f32_bf16 v135, v47, v29, v135
    s_waitcnt lgkmcnt(7)
    v_lshlrev_b32 v28, 16, v14
    s_waitcnt vmcnt(19)
    v_dot2_f32_bf16 v128, v48, v14, v128
    v_dot2_f32_bf16 v129, v48, v28, v129
    v_dot2_f32_bf16 v130, v49, v14, v130
    v_dot2_f32_bf16 v131, v49, v28, v131
    v_dot2_f32_bf16 v132, v50, v14, v132
    v_dot2_f32_bf16 v133, v50, v28, v133
    v_dot2_f32_bf16 v134, v51, v14, v134
    v_dot2_f32_bf16 v135, v51, v28, v135
    s_waitcnt lgkmcnt(6)
    v_lshlrev_b32 v29, 16, v15
    s_waitcnt vmcnt(18)
    v_dot2_f32_bf16 v128, v52, v15, v128
    v_dot2_f32_bf16 v129, v52, v29, v129
    v_dot2_f32_bf16 v130, v53, v15, v130
    v_dot2_f32_bf16 v131, v53, v29, v131
    v_dot2_f32_bf16 v132, v54, v15, v132
    v_dot2_f32_bf16 v133, v54, v29, v133
    v_dot2_f32_bf16 v134, v55, v15, v134
    v_dot2_f32_bf16 v135, v55, v29, v135
    s_waitcnt lgkmcnt(5)
    v_lshlrev_b32 v28, 16, v16
    s_waitcnt vmcnt(17)
    v_dot2_f32_bf16 v128, v56, v16, v128
    v_dot2_f32_bf16 v129, v56, v28, v129
    v_dot2_f32_bf16 v130, v57, v16, v130
    v_dot2_f32_bf16 v131, v57, v28, v131
    v_dot2_f32_bf16 v132, v58, v16, v132
    v_dot2_f32_bf16 v133, v58, v28, v133
    v_dot2_f32_bf16 v134, v59, v16, v134
    v_dot2_f32_bf16 v135, v59, v28, v135
    s_waitcnt lgkmcnt(4)
    v_lshlrev_b32 v29, 16, v17
    s_waitcnt vmcnt(16)
    v_dot2_f32_bf16 v128, v60, v17, v128
    v_dot2_f32_bf16 v129, v60, v29, v129
    v_dot2_f32_bf16 v130, v61, v17, v130
    v_dot2_f32_bf16 v131, v61, v29, v131
    v_dot2_f32_bf16 v132, v62, v17, v132
    v_dot2_f32_bf16 v133, v62, v29, v133
    v_dot2_f32_bf16 v134, v63, v17, v134
    v_dot2_f32_bf16 v135, v63, v29, v135
    s_waitcnt lgkmcnt(3)
    v_lshlrev_b32 v28, 16, v18
    s_waitcnt vmcnt(15)
    v_dot2_f32_bf16 v128, v64, v18, v128
    v_dot2_f32_bf16 v129, v64, v28, v129
    v_dot2_f32_bf16 v130, v65, v18, v130
    v_dot2_f32_bf16 v131, v65, v28, v131
    v_dot2_f32_bf16 v132, v66, v18, v132
    v_dot2_f32_bf16 v133, v66, v28, v133
    v_dot2_f32_bf16 v134, v67, v18, v134
    v_dot2_f32_bf16 v135, v67, v28, v135
    s_waitcnt lgkmcnt(2)
    v_lshlrev_b32 v29, 16, v19
    s_waitcnt vmcnt(14)
    v_dot2_f32_bf16 v128, v68, v19, v128
    v_dot2_f32_bf16 v129, v68, v29, v129
    v_dot2_f32_bf16 v130, v69, v19, v130
    v_dot2_f32_bf16 v131, v69, v29, v131
    v_dot2_f32_bf16 v132, v70, v19, v132
    v_dot2_f32_bf16 v133, v70, v29, v133
    v_dot2_f32_bf16 v134, v71, v19, v134
    v_dot2_f32_bf16 v135, v71, v29, v135
    s_waitcnt lgkmcnt(1)
    v_lshlrev_b32 v28, 16, v20
    s_waitcnt vmcnt(13)
    v_dot2_f32_bf16 v128, v72, v20, v128
    v_dot2_f32_bf16 v129, v72, v28, v129
    v_dot2_f32_bf16 v130, v73, v20, v130
    v_dot2_f32_bf16 v131, v73, v28, v131
    v_dot2_f32_bf16 v132, v74, v20, v132
    v_dot2_f32_bf16 v133, v74, v28, v133
    v_dot2_f32_bf16 v134, v75, v20, v134
    v_dot2_f32_bf16 v135, v75, v28, v135
    s_waitcnt lgkmcnt(0)
    v_lshlrev_b32 v29, 16, v21
    s_waitcnt vmcnt(12)
    v_dot2_f32_bf16 v128, v76, v21, v128
    v_dot2_f32_bf16 v129, v76, v29, v129
    v_dot2_f32_bf16 v130, v77, v21, v130
    v_dot2_f32_bf16 v131, v77, v29, v131
    v_dot2_f32_bf16 v132, v78, v21, v132
    v_dot2_f32_bf16 v133, v78, v29, v133
    v_dot2_f32_bf16 v134, v79, v21, v134
    v_dot2_f32_bf16 v135, v79, v29, v135
    s_nop 2
    ds_read_u16 v10, v2 offset:1288
    ds_read_u16 v11, v2 offset:1294
    ds_read_u16 v12, v2 offset:1300
    ds_read_u16 v13, v2 offset:1306
    ds_read_u16 v14, v2 offset:1312
    ds_read_u16 v15, v2 offset:1318
    ds_read_u16 v16, v2 offset:1324
    ds_read_u16 v17, v2 offset:1330
    ds_read_u16 v18, v2 offset:1336
    ds_read_u16 v19, v2 offset:1342
    ds_read_u16 v20, v2 offset:1348
    ds_read_u16 v21, v2 offset:1354
    s_waitcnt lgkmcnt(11)
    v_lshlrev_b32 v28, 16, v10
    s_waitcnt vmcnt(11)
    v_dot2_f32_bf16 v128, v80, v10, v128
    v_dot2_f32_bf16 v129, v80, v28, v129
    v_dot2_f32_bf16 v130, v81, v10, v130
    v_dot2_f32_bf16 v131, v81, v28, v131
    v_dot2_f32_bf16 v132, v82, v10, v132
    v_dot2_f32_bf16 v133, v82, v28, v133
    v_dot2_f32_bf16 v134, v83, v10, v134
    v_dot2_f32_bf16 v135, v83, v28, v135
    s_waitcnt lgkmcnt(10)
    v_lshlrev_b32 v29, 16, v11
    s_waitcnt vmcnt(10)
    v_dot2_f32_bf16 v128, v84, v11, v128
    v_dot2_f32_bf16 v129, v84, v29, v129
    v_dot2_f32_bf16 v130, v85, v11, v130
    v_dot2_f32_bf16 v131, v85, v29, v131
    v_dot2_f32_bf16 v132, v86, v11, v132
    v_dot2_f32_bf16 v133, v86, v29, v133
    v_dot2_f32_bf16 v134, v87, v11, v134
    v_dot2_f32_bf16 v135, v87, v29, v135
    s_waitcnt lgkmcnt(9)
    v_lshlrev_b32 v28, 16, v12
    s_waitcnt vmcnt(9)
    v_dot2_f32_bf16 v128, v88, v12, v128
    v_dot2_f32_bf16 v129, v88, v28, v129
    v_dot2_f32_bf16 v130, v89, v12, v130
    v_dot2_f32_bf16 v131, v89, v28, v131
    v_dot2_f32_bf16 v132, v90, v12, v132
    v_dot2_f32_bf16 v133, v90, v28, v133
    v_dot2_f32_bf16 v134, v91, v12, v134
    v_dot2_f32_bf16 v135, v91, v28, v135
    s_waitcnt lgkmcnt(8)
    v_lshlrev_b32 v29, 16, v13
    s_waitcnt vmcnt(8)
    v_dot2_f32_bf16 v128, v92, v13, v128
    v_dot2_f32_bf16 v129, v92, v29, v129
    v_dot2_f32_bf16 v130, v93, v13, v130
    v_dot2_f32_bf16 v131, v93, v29, v131
    v_dot2_f32_bf16 v132, v94, v13, v132
    v_dot2_f32_bf16 v133, v94, v29, v133
    v_dot2_f32_bf16 v134, v95, v13, v134
    v_dot2_f32_bf16 v135, v95, v29, v135
    s_waitcnt lgkmcnt(7)
    v_lshlrev_b32 v28, 16, v14
    s_waitcnt vmcnt(7)
    v_dot2_f32_bf16 v128, v96, v14, v128
    v_dot2_f32_bf16 v129, v96, v28, v129
    v_dot2_f32_bf16 v130, v97, v14, v130
    v_dot2_f32_bf16 v131, v97, v28, v131
    v_dot2_f32_bf16 v132, v98, v14, v132
    v_dot2_f32_bf16 v133, v98, v28, v133
    v_dot2_f32_bf16 v134, v99, v14, v134
    v_dot2_f32_bf16 v135, v99, v28, v135
    s_waitcnt lgkmcnt(6)
    v_lshlrev_b32 v29, 16, v15
    s_waitcnt vmcnt(6)
    v_dot2_f32_bf16 v128, v100, v15, v128
    v_dot2_f32_bf16 v129, v100, v29, v129
    v_dot2_f32_bf16 v130, v101, v15, v130
    v_dot2_f32_bf16 v131, v101, v29, v131
    v_dot2_f32_bf16 v132, v102, v15, v132
    v_dot2_f32_bf16 v133, v102, v29, v133
    v_dot2_f32_bf16 v134, v103, v15, v134
    v_dot2_f32_bf16 v135, v103, v29, v135
    s_waitcnt lgkmcnt(5)
    v_lshlrev_b32 v28, 16, v16
    s_waitcnt vmcnt(5)
    v_dot2_f32_bf16 v128, v104, v16, v128
    v_dot2_f32_bf16 v129, v104, v28, v129
    v_dot2_f32_bf16 v130, v105, v16, v130
    v_dot2_f32_bf16 v131, v105, v28, v131
    v_dot2_f32_bf16 v132, v106, v16, v132
    v_dot2_f32_bf16 v133, v106, v28, v133
    v_dot2_f32_bf16 v134, v107, v16, v134
    v_dot2_f32_bf16 v135, v107, v28, v135
    s_waitcnt lgkmcnt(4)
    v_lshlrev_b32 v29, 16, v17
    s_waitcnt vmcnt(4)
    v_dot2_f32_bf16 v128, v108, v17, v128
    v_dot2_f32_bf16 v129, v108, v29, v129
    v_dot2_f32_bf16 v130, v109, v17, v130
    v_dot2_f32_bf16 v131, v109, v29, v131
    v_dot2_f32_bf16 v132, v110, v17, v132
    v_dot2_f32_bf16 v133, v110, v29, v133
    v_dot2_f32_bf16 v134, v111, v17, v134
    v_dot2_f32_bf16 v135, v111, v29, v135
    s_waitcnt lgkmcnt(3)
    v_lshlrev_b32 v28, 16, v18
    s_waitcnt vmcnt(3)
    v_dot2_f32_bf16 v128, v112, v18, v128
    v_dot2_f32_bf16 v129, v112, v28, v129
    v_dot2_f32_bf16 v130, v113, v18, v130
    v_dot2_f32_bf16 v131, v113, v28, v131
    v_dot2_f32_bf16 v132, v114, v18, v132
    v_dot2_f32_bf16 v133, v114, v28, v133
    v_dot2_f32_bf16 v134, v115, v18, v134
    v_dot2_f32_bf16 v135, v115, v28, v135
    s_waitcnt lgkmcnt(2)
    v_lshlrev_b32 v29, 16, v19
    s_waitcnt vmcnt(2)
    v_dot2_f32_bf16 v128, v116, v19, v128
    v_dot2_f32_bf16 v129, v116, v29, v129
    v_dot2_f32_bf16 v130, v117, v19, v130
    v_dot2_f32_bf16 v131, v117, v29, v131
    v_dot2_f32_bf16 v132, v118, v19, v132
    v_dot2_f32_bf16 v133, v118, v29, v133
    v_dot2_f32_bf16 v134, v119, v19, v134
    v_dot2_f32_bf16 v135, v119, v29, v135
    s_waitcnt lgkmcnt(1)
    v_lshlrev_b32 v28, 16, v20
    s_waitcnt vmcnt(1)
    v_dot2_f32_bf16 v128, v120, v20, v128
    v_dot2_f32_bf16 v129, v120, v28, v129
    v_dot2_f32_bf16 v130, v121, v20, v130
    v_dot2_f32_bf16 v131, v121, v28, v131
    v_dot2_f32_bf16 v132, v122, v20, v132
    v_dot2_f32_bf16 v133, v122, v28, v133
    v_dot2_f32_bf16 v134, v123, v20, v134
    v_dot2_f32_bf16 v135, v123, v28, v135
    s_waitcnt lgkmcnt(0)
    v_lshlrev_b32 v29, 16, v21
    s_waitcnt vmcnt(0)
    v_dot2_f32_bf16 v128, v124, v21, v128
    v_dot2_f32_bf16 v129, v124, v29, v129
    v_dot2_f32_bf16 v130, v125, v21, v130
    v_dot2_f32_bf16 v131, v125, v29, v131
    v_dot2_f32_bf16 v132, v126, v21, v132
    v_dot2_f32_bf16 v133, v126, v29, v133
    v_dot2_f32_bf16 v134, v127, v21, v134
    v_dot2_f32_bf16 v135, v127, v29, v135
    s_nop 2
    v_lshlrev_b32 v2, 5, v1
    ds_write_b128 v2, v[128:131] offset:47616
    ds_write_b128 v2, v[132:135] offset:47632
    v_lshlrev_b32 v2, 3, v1
    s_waitcnt lgkmcnt(0)
    ds_read_b64 v[32:33], v2 offset:47616
    ds_read_b64 v[34:35], v2 offset:48192
    ds_read_b64 v[36:37], v2 offset:48768
    ds_read_b64 v[40:41], v2 offset:48128
    ds_read_b64 v[42:43], v2 offset:48704
    ds_read_b64 v[44:45], v2 offset:49280
    s_waitcnt lgkmcnt(0)
    v_add_f32 v32, v32, v34
    v_add_f32 v32, v32, v36
    v_add_f32 v33, v33, v35
    v_add_f32 v33, v33, v37
    v_add_f32 v40, v40, v42
    v_add_f32 v40, v40, v44
    v_add_f32 v41, v41, v43
    v_add_f32 v41, v41, v45
    v_mov_b32 v12, s16
    v_mov_b32 v13, v32
    v_mov_b32 v14, v33
    v_mov_b32 v15, s17
    v_mov_b32 v16, s16
    v_mov_b32 v17, v40
    v_mov_b32 v18, v41
    v_mov_b32 v19, s17
    v_lshlrev_b32 v2, 4, v1
    s_lshl_b32 s9, s2, 13
    buffer_store_dwordx4 v[12:15], v2, s[88:91], s9 offen offset:1024 sc1
    v_cmp_gt_u32 vcc, 8, v1
    s_and_saveexec_b64 s[20:21], vcc
    buffer_store_dwordx4 v[16:19], v2, s[88:91], s9 offen offset:2048 sc1
    s_mov_b64 exec, s[20:21]
    v_min_u32 v7, 35, v1
    s_lshr_b32 s8, s5, 2
    s_mul_i32 s9, s4, 576
    s_mul_i32 s10, s8, 144
    s_add_u32 s9, s9, s10
    v_lshl_add_u32 v6, v7, 2, s9
    global_load_dword v30, v6, s[50:51]
    v_lshlrev_b32 v7, 4, v7
    s_lshl_b32 s9, s4, 17
    s_lshr_b32 s10, s5, 3
    s_lshl_b32 s10, s10, 16
    s_add_u32 s9, s9, s10
    s_and_b32 s10, s8, 1
    s_mul_i32 s10, s10, 576
    s_add_u32 s9, s9, s10
    v_mov_b32 v10, 3076
    s_mov_b32 s12, 0
L_spin_36:
    ds_read_b32 v11, v10
    s_add_u32 s12, s12, 1
    s_waitcnt lgkmcnt(0)
    v_cmp_ne_u32 vcc, 0, v11
    s_cmp_gt_u32 s12, 1600000
    s_cbranch_scc1 L_spind_37
    s_cbranch_vccnz L_spind_37
    s_sleep 4
    s_branch L_spin_36
L_spind_37:
    s_mov_b32 s12, 0
L_poll_38:
    s_add_u32 s10, s9, 1024
    buffer_load_dwordx4 v[32:35], v7, s[88:91], s10 offen sc1
    s_add_u32 s10, s9, 9216
    buffer_load_dwordx4 v[36:39], v7, s[88:91], s10 offen sc1
    s_add_u32 s10, s9, 17408
    buffer_load_dwordx4 v[40:43], v7, s[88:91], s10 offen sc1
    s_add_u32 s10, s9, 25600
    buffer_load_dwordx4 v[44:47], v7, s[88:91], s10 offen sc1
    s_add_u32 s10, s9, 33792
    buffer_load_dwordx4 v[48:51], v7, s[88:91], s10 offen sc1
    s_add_u32 s10, s9, 41984
    buffer_load_dwordx4 v[52:55], v7, s[88:91], s10 offen sc1
    s_add_u32 s10, s9, 50176
    buffer_load_dwordx4 v[56:59], v7, s[88:91], s10 offen sc1
    s_add_u32 s10, s9, 58368
    buffer_load_dwordx4 v[60:63], v7, s[88:91], s10 offen sc1
    s_add_u32 s12, s12, 1
    s_waitcnt vmcnt(0)
    v_xor_b32 v21, s16, v32
    v_xor_b32 v22, s17, v35
    v_or_b32 v20, v21, v22
    v_xor_b32 v21, s16, v36
    v_xor_b32 v22, s17, v39
    v_or3_b32 v20, v20, v21, v22
    v_xor_b32 v21, s16, v40
    v_xor_b32 v22, s17, v43
    v_or3_b32 v20, v20, v21, v22
    v_xor_b32 v21, s16, v44
    v_xor_b32 v22, s17, v47
    v_or3_b32 v20, v20, v21, v22
    v_xor_b32 v21, s16, v48
    v_xor_b32 v22, s17, v51
    v_or3_b32 v20, v20, v21, v22
    v_xor_b32 v21, s16, v52
    v_xor_b32 v22, s17, v55
    v_or3_b32 v20, v20, v21, v22
    v_xor_b32 v21, s16, v56
    v_xor_b32 v22, s17, v59
    v_or3_b32 v20, v20, v21, v22
    v_xor_b32 v21, s16, v60
    v_xor_b32 v22, s17, v63
    v_or3_b32 v20, v20, v21, v22
    v_cmp_ne_u32 vcc, 0, v20
    s_cmp_gt_u32 s12, 400000
    s_cbranch_scc1 L_polld_39
    s_cbranch_vccz L_polld_39
    s_sleep 2
    s_branch L_poll_38
L_polld_39:
    v_add_f32 v33, v33, v49
    v_add_f32 v34, v34, v50
    v_add_f32 v37, v37, v53
    v_add_f32 v38, v38, v54
    v_add_f32 v41, v41, v57
    v_add_f32 v42, v42, v58
    v_add_f32 v45, v45, v61
    v_add_f32 v46, v46, v62
    v_add_f32 v33, v33, v41
    v_add_f32 v34, v34, v42
    v_add_f32 v37, v37, v45
    v_add_f32 v38, v38, v46
    v_add_f32 v33, v33, v37
    v_add_f32 v34, v34, v38
    v_cvt_pk_bf16_f32 v35, v33, v34
    v_lshlrev_b32 v33, 16, v35
    v_and_b32 v34, s25, v35
    v_lshlrev_b32 v36, 16, v30
    v_and_b32 v37, s25, v30
    v_add_f32 v33, v33, v36
    v_add_f32 v34, v34, v37
    v_cvt_pk_bf16_f32 v35, v33, v34
    v_lshlrev_b32 v33, 16, v35
    v_and_b32 v34, s25, v35
    v_mul_f32 v40, v33, v33
    v_mul_f32 v40, v40, v33
    v_mov_b32 v42, v33
    v_fmac_f32 v42, 0x3d372713, v40
    v_mul_f32 v42, 0x40135761, v42
    v_exp_f32 v42, v42
    s_nop 0
    v_add_f32 v42, 1.0, v42
    v_rcp_f32 v42, v42
    s_nop 0
    v_fma_f32 v42, -2.0, v42, 1.0
    v_add_f32 v42, 1.0, v42
    v_mul_f32 v40, 0.5, v33
    v_mul_f32 v42, v40, v42
    v_mul_f32 v41, v34, v34
    v_mul_f32 v41, v41, v34
    v_mov_b32 v43, v34
    v_fmac_f32 v43, 0x3d372713, v41
    v_mul_f32 v43, 0x40135761, v43
    v_exp_f32 v43, v43
    s_nop 0
    v_add_f32 v43, 1.0, v43
    v_rcp_f32 v43, v43
    s_nop 0
    v_fma_f32 v43, -2.0, v43, 1.0
    v_add_f32 v43, 1.0, v43
    v_mul_f32 v41, 0.5, v34
    v_mul_f32 v43, v41, v43
    v_cvt_pk_bf16_f32 v35, v42, v43
    v_cmp_gt_u32 vcc, 36, v1
    s_nop 1
    v_cndmask_b32 v35, 0, v35, vcc
    v_lshlrev_b32 v4, 2, v1
    v_cmp_gt_u32 vcc, 48, v1
    s_and_saveexec_b64 s[20:21], vcc
    ds_write_b32 v4, v35 offset:4992
    s_mov_b64 exec, s[20:21]
    s_waitcnt lgkmcnt(0)
    v_mov_b32 v10, 3100
    v_mov_b32 v11, 1
    ds_write_b32 v10, v11
    s_waitcnt lgkmcnt(0)
    s_endpgm
L_w2b:
    s_barrier
    s_waitcnt vmcnt(0)
    s_nop 0
    v_readfirstlane_b32 s10, v14
    v_readfirstlane_b32 s11, v15
    s_cmp_eq_u32 s10, 0
    s_cselect_b32 s16, s16, s10
    s_cselect_b32 s17, s17, s11
    v_mov_b32 v4, s16
    v_mov_b32 v5, s17
    v_mov_b32 v12, 3088
    ds_write_b64 v12, v[4:5]
    s_waitcnt lgkmcnt(0)
    s_cmp_ge_u32 s2, 72
    s_cbranch_scc1 L_w2end
    v_mov_b32 v12, 3076
    s_mov_b32 s12, 0
L_spin_40:
    ds_read_b32 v13, v12
    s_add_u32 s12, s12, 1
    s_waitcnt lgkmcnt(0)
    v_cmp_ne_u32 vcc, 0, v13
    s_cmp_gt_u32 s12, 1600000
    s_cbranch_scc1 L_spind_41
    s_cbranch_vccnz L_spind_41
    s_sleep 8
    s_branch L_spin_40
L_spind_41:
    v_and_b32 v2, 15, v1
    v_and_b32 v3, 3, v2
    v_lshlrev_b32 v3, 6, v3
    v_lshrrev_b32 v4, 2, v2
    v_lshl_add_u32 v3, v4, 3, v3
    s_mov_b32 s12, 0
L_np_42:
    global_load_dwordx2 v[4:5], v3, s[58:59] sc1
    s_add_u32 s12, s12, 1
    s_waitcnt vmcnt(0)
    v_cmp_eq_u32 vcc, 0, v4
    s_cmp_gt_u32 s12, 400000
    s_cbranch_scc1 L_npd_43
    s_cbranch_vccz L_npd_43
    s_sleep 8
    s_branch L_np_42
L_npd_43:
    v_lshlrev_b32 v2, 3, v2
    ds_write_b64 v2, v[4:5] offset:3264
    s_waitcnt lgkmcnt(0)
    v_mov_b32 v10, 3080
    v_mov_b32 v11, 1
    ds_write_b32 v10, v11
    s_waitcnt lgkmcnt(0)
L_w2end:
    s_endpgm
L_end:
    s_endpgm
.section .rodata,"a"
.p2align 6
.amdhsa_kernel parallel_sum__sliding_block_cached__mixer_channel_mlp__decode_kernel
  .amdhsa_next_free_vgpr 168
  .amdhsa_next_free_sgpr 102
  .amdhsa_accum_offset 168
  .amdhsa_group_segment_fixed_size 0
  .amdhsa_kernarg_size 104
  .amdhsa_user_sgpr_count 2
  .amdhsa_user_sgpr_kernarg_segment_ptr 1
  .amdhsa_system_sgpr_workgroup_id_x 1
.end_amdhsa_kernel
```
